```python
import torch

def _softmax(x, axis=-1):
    return torch.softmax(x, dim=axis)
def _gelu(x):
    return torch.nn.functional.gelu(x, approximate="tanh")
def _silu(x):
    return torch.nn.functional.silu(x)
def _sigmoid(x):
    return torch.sigmoid(x)
def _layernorm(x, axis=-1, eps=1e-5):
    m = x.mean(dim=axis, keepdim=True)
    v = x.var(dim=axis, keepdim=True, unbiased=False)
    return (x - m) / torch.sqrt(v + eps)
def _scatter_add(tgt, idx, src, axis=0):
    return tgt.clone().index_add_(axis, idx, src)
def _segment_sum(src, seg, n):
    out = torch.zeros((n,) + src.shape[1:], dtype=src.dtype)
    return out.index_add_(0, seg, src)
def _pad(x, pw):
    flat = tuple(v for pair in reversed(pw) for v in pair)
    return torch.nn.functional.pad(x, flat)

kernel_name = 'gated_mix__ssm_conv_s4d__spectral_gfnet__prompt'

def setup_inputs():

    _w = (lambda a: (lambda t: t.to(torch.bfloat16) if t.is_floating_point() else t)(torch.as_tensor(a)))
    def _A_setup():
        Bsz, L, D, N = 1, 2048, 1024, 128
        return {
            "u": _w((lambda *s: torch.randn(*s, dtype=torch.bfloat16) * 0.05)(Bsz, L, D)),
            "log_A_real": _w((lambda *s: torch.randn(*s, dtype=torch.bfloat16) * 6.4)(D, N) * 0.5),
            "A_imag": _w((lambda *s: torch.randn(*s, dtype=torch.bfloat16) * 0.05)(D, N) * 3.14),
            "C_real": _w((lambda *s: torch.randn(*s, dtype=torch.bfloat16) * 0.05)(D, N) / N ** 0.5),
            "C_imag": _w((lambda *s: torch.randn(*s, dtype=torch.bfloat16) * 0.05)(D, N) / N ** 0.5),
            "log_dt": _w((lambda *s: torch.randn(*s, dtype=torch.bfloat16) * 0.05)(D) * 0.5 - 4.0),
            "D_skip": _w((lambda *s: torch.randn(*s, dtype=torch.bfloat16) * 0.05)(D)),
        }
    _A_in = _A_setup()

    def _B_setup():
        B, S, D = 1, 2048, 1024
        Df = D // 2 + 1
        return {
            "x": _w((lambda *s: torch.randn(*s, dtype=torch.bfloat16) * 0.05)(B, S, D)),
            "w_r": _w((lambda *s: torch.randn(*s, dtype=torch.bfloat16) * 0.8)(S, Df) * 0.02),
            "w_i": _w((lambda *s: torch.randn(*s, dtype=torch.bfloat16) * 0.8)(S, Df) * 0.02),
        }
    _B_in = _B_setup()

    return {
        "A_u": _A_in["u"],
        "A_log_A_real": _A_in["log_A_real"],
        "A_A_imag": _A_in["A_imag"],
        "A_C_real": _A_in["C_real"],
        "A_C_imag": _A_in["C_imag"],
        "A_log_dt": _A_in["log_dt"],
        "A_D_skip": _A_in["D_skip"],
        "B_x": _B_in["x"],
        "B_w_r": _B_in["w_r"],
        "B_w_i": _B_in["w_i"],
        "gate_w": _w((lambda *s: torch.randn(*s, dtype=torch.bfloat16) * 0.05)(1024) * 16.0),
    }

def reference(A_u, A_log_A_real, A_A_imag, A_C_real, A_C_imag, A_log_dt, A_D_skip, B_x, B_w_r, B_w_i, gate_w):
    def _A_ref(u, log_A_real, A_imag, C_real, C_imag, log_dt, D_skip):
        L = u.shape[1]
        dt = torch.exp(log_dt)
        A = -torch.exp(log_A_real) + 1j * A_imag
        C = (C_real + 1j * C_imag) * dt[:, None]
        pos = (lambda x, dt: x.to(dt))(torch.arange(L), log_dt.dtype)
        P = torch.exp((A * dt[:, None])[:, :, None] * pos[None, None, :])
        K = 2.0 * torch.einsum("dn,dnl->dl", C, P).real
        L2 = 2 * L
        u_t = (lambda x, *d: x.permute(*d))(u, 0, 2, 1)
        Kf = (lambda x, *a, **k: torch.fft.rfft(x.float(), *a, **k))(K, L2)
        Uf = (lambda x, *a, **k: torch.fft.rfft(x.float(), *a, **k))(u_t, L2)
        y = (lambda x, *a, **k: torch.fft.irfft(x, *a, **k).to(torch.bfloat16))(Uf * Kf[None, :, :], L2)[:, :, :L]
        y = (lambda x, *d: x.permute(*d))(y, 0, 2, 1)
        return y + u * D_skip[None, None, :]

    def _B_ref(x, w_r, w_i):
        B, S, D = x.shape
        X = (lambda x, axes=(-2,-1): torch.fft.rfft2(x.float(), dim=axes))(x, axes=(-2, -1))
        W = w_r + 1j * w_i
        X = X * W
        y = (lambda x, s, axes=(-2,-1): torch.fft.irfft2(x, s=s, dim=axes).to(torch.bfloat16))(X, (S, D), axes=(-2, -1))
        return y

    x = A_u
    g = _sigmoid((x * gate_w).sum(-1, keepdims=True))
    a = _A_ref(x, A_log_A_real, A_A_imag, A_C_real, A_C_imag, A_log_dt, A_D_skip)
    b = _B_ref(x, B_w_r, B_w_i)
    return g * a + (1 - g) * b
```

```asm
; @launch grid=(256,1,1) block=(256,1,1) lds=111616
.amdgcn_target "amdgcn-amd-amdhsa--gfx950"
.text
.globl gated_mix__ssm_conv_s4d__spectral_gfnet__prompt_kernel
.p2align 8
.type gated_mix__ssm_conv_s4d__spectral_gfnet__prompt_kernel,@function
gated_mix__ssm_conv_s4d__spectral_gfnet__prompt_kernel:
    s_cmp_ge_u32 s2, 0x100
    s_cbranch_scc1 k_end
    s_load_dwordx2 s[4:5], s[0:1], 0x68
    s_load_dwordx16 s[20:35], s[0:1], 0
    s_load_dwordx8 s[36:43], s[0:1], 64
    s_getpc_b64 s[16:17]
k_pc:
    s_mov_b32 s18, code_end-k_pc
    s_mov_b32 s19, 0x20000
    s_lshr_b32 s58, s2, 3
    s_lshl_b32 s58, s58, 10
    v_and_b32 v4, 15, v0
    v_lshlrev_b32 v4, 6, v4
    buffer_load_dword v11, v4, s[16:19], s58 offen
    v_lshrrev_b32 v2, 6, v0
    v_and_b32 v1, 15, v0
    v_readfirstlane_b32 s3, v2
    v_bfe_u32 v2, v0, 4, 2
    v_and_b32 v3, 63, v0
    s_mov_b32 s6, 0x1400000
    s_mov_b32 s7, 0x20000
    s_mov_b32 s10, 0x400000
    s_mov_b32 s11, 0x20000
    s_mov_b32 s14, 0x800
    s_mov_b32 s15, 0x20000
    s_and_b32 s44, s2, 7
    s_lshr_b32 s45, s2, 3
    s_lshl_b32 s46, s44, 5
    s_add_u32 s46, s46, s45
    s_lshl_b32 s47, s3, 9
    s_add_u32 s47, s47, s46
    s_lshl_b32 s48, s46, 2
    s_add_u32 s48, s48, s3
    v_lshrrev_b32 v4, 1, v1
    v_lshlrev_b32 v4, 4, v4
    v_lshl_add_u32 v4, v2, 9, v4
    v_and_b32 v5, 1, v1
    v_lshl_add_u32 v5, v5, 19, v4
    s_lshl_b32 s49, s47, 11
    s_and_b32 s50, s45, 7
    s_lshl_b32 s50, s50, 3
    s_add_u32 s50, s50, s44
    s_lshr_b32 s51, s45, 3
    s_lshl_b32 s51, s51, 2
    s_add_u32 s51, s51, s3
    s_lshl_b32 s52, s50, 16
    s_lshl_b32 s53, s51, 7
    s_add_u32 s52, s52, s53
    v_lshlrev_b32 v6, 3, v1
    v_lshl_add_u32 v6, v2, 14, v6
    s_lshl_b32 s53, s48, 8
    v_lshl_add_u32 v7, v3, 2, s53
    s_lshl_b32 s59, s48, 1
    s_and_b32 s59, s59, -4
    s_mov_b32 s58, 0x1214000
    s_waitcnt lgkmcnt(0)
    s_mov_b32 s8, s20
    s_mov_b32 s9, s21
    s_mov_b32 s12, s40
    s_mov_b32 s13, s41
    s_load_dword s56, s[4:5], s58
    s_load_dword s40, s[30:31], s59
    s_load_dword s41, s[32:33], s59
    buffer_load_dwordx4 v[12:15], v5, s[8:11], s49 offen
    buffer_load_dwordx4 v[16:19], v5, s[8:11], s49 offen offset:128
    buffer_load_dwordx4 v[20:23], v5, s[8:11], s49 offen offset:256
    buffer_load_dwordx4 v[24:27], v5, s[8:11], s49 offen offset:384
    v_mov_b32 v50, v6
    v_mov_b32 v51, v7
    v_mov_b32 v52, v4
    s_mov_b32 s34, s52
    global_load_dword v44, v51, s[22:23]
    global_load_dword v45, v51, s[24:25]
    global_load_dword v46, v51, s[26:27]
    global_load_dword v47, v51, s[28:29]
    buffer_load_dwordx4 a[152:155], v52, s[12:15], 0 offen
    buffer_load_dwordx4 a[156:159], v52, s[12:15], 0 offen offset:128
    buffer_load_dwordx4 a[160:163], v52, s[12:15], 0 offen offset:256
    buffer_load_dwordx4 a[164:167], v52, s[12:15], 0 offen offset:384
    v_and_b32 v8, 7, v1
    v_mul_u32_u24 v8, 0x402, v8
    s_mul_i32 s53, s46, 0x2010
    s_cmp_eq_u32 s3, 3
    s_cbranch_scc0 k_now256
    s_mov_b32 s16, s36
    s_mov_b32 s17, s37
    s_mov_b32 s18, 0x201000
    s_mov_b32 s19, 0x20000
    buffer_load_ushort v48, v8, s[16:19], s53 offen offset:512
    s_mov_b32 s16, s38
    s_mov_b32 s17, s39
    buffer_load_ushort v49, v8, s[16:19], s53 offen offset:512
k_now256:
    v_cvt_f32_u32 v5, v1
    v_cvt_f32_u32 v6, v2
    v_mul_f32 v8, v5, v6
    v_mul_f32 v7, 0x3d800000, v5
    v_mul_f32 v8, 0x3e800000, v8
    v_fma_f32 v9, v7, 0.5, v8
    v_cos_f32 v105, v9
    v_sin_f32 v106, v9
    v_add_f32 v92, v8, v7
    v_add_f32 v108, v9, v7
    v_add_f32 v96, v92, v7
    v_add_f32 v112, v108, v7
    v_mul_f32 v9, 0x3d800000, v8
    v_add_f32 v100, v96, v7
    v_add_f32 v116, v112, v7
    v_cos_f32 v72, v9
    v_sin_f32 v73, v9
    v_mul_f32 v7, 0x3b000000, v5
    v_add_f32 v9, v9, v7
    v_cos_f32 v74, v9
    v_sin_f32 v75, v9
    v_add_f32 v9, v9, v7
    v_cos_f32 v76, v9
    v_sin_f32 v77, v9
    v_add_f32 v9, v9, v7
    v_cos_f32 v78, v9
    v_sin_f32 v79, v9
    v_add_f32 v9, v9, v7
    v_cos_f32 v80, v9
    v_sin_f32 v81, v9
    v_add_f32 v9, v9, v7
    v_cos_f32 v82, v9
    v_sin_f32 v83, v9
    v_add_f32 v9, v9, v7
    v_cos_f32 v84, v9
    v_sin_f32 v85, v9
    v_cos_f32 v89, v8
    v_sin_f32 v90, v8
    v_add_f32 v9, v9, v7
    v_and_b32 v7, 7, v1
    v_and_b32 v8, 1, v2
    v_cvt_f32_u32 v7, v7
    v_cvt_f32_u32 v8, v8
    v_cos_f32 v86, v9
    v_sin_f32 v87, v9
    v_mul_f32 v7, 0x3e000000, v7
    v_mul_f32 v8, 4.0, v8
    v_cos_f32 v93, v92
    v_sin_f32 v94, v92
    v_mul_f32 v8, v8, v7
    v_cos_f32 v97, v96
    v_sin_f32 v98, v96
    v_lshrrev_b32 v9, 3, v1
    v_lshrrev_b32 v10, 1, v2
    v_add_f32 v92, v8, v7
    v_cos_f32 v101, v100
    v_sin_f32 v102, v100
    v_cmp_eq_u32 vcc, v9, v10
    v_add_f32 v96, v92, v7
    v_cvt_pk_bf16_f32 v248, v89, v90
    v_cvt_pk_bf16_f32 v252, -v90, v89
    v_add_f32 v100, v96, v7
    v_cos_f32 v89, v8
    v_sin_f32 v90, v8
    v_bfe_u32 v7, v1, 2, 1
    s_lshr_b32 s20, s3, 1
    v_xor_b32 v8, s20, v7
    v_lshlrev_b32 v8, 4, v8
    v_lshlrev_b32 v10, 31, v10
    v_cndmask_b32 v120, 0, 1.0, vcc
    v_lshl_add_u32 v8, v1, 5, v8
    v_xor_b32 v121, v120, v10
    v_lshl_add_u32 v8, v2, 11, v8
    s_and_b32 s21, s3, 1
    s_lshl_b32 s21, s21, 3
    v_add_u32 v54, s21, v8
    v_lshrrev_b32 v10, 1, v2
    v_sub_u32 v8, 0, v10
    v_xor_b32 v9, v1, v8
    v_add_u32 v9, v9, v10
    v_bfe_u32 v7, v9, 2, 1
    v_and_b32 v88, 1, v2
    v_xor_b32 v7, v7, v88
    v_lshlrev_b32 v7, 4, v7
    v_lshl_add_u32 v9, v9, 5, v7
    v_xor_b32 v7, 0x200, v8
    v_add_u32 v7, v7, v10
    s_lshl_b32 s52, s3, 2
    v_lshl_add_u32 v180, v7, 4, v9
    v_mul_lo_u32 v88, v7, s52
    v_add_u32 v9, v9, v88
    v_and_b32 v176, 0x3fff, v9
    v_add_u32 v9, v9, v7
    v_and_b32 v177, 0x3fff, v9
    v_add_u32 v9, v9, v7
    v_and_b32 v178, 0x3fff, v9
    v_add_u32 v9, v9, v7
    v_cvt_pk_bf16_f32 v249, v93, v94
    v_cvt_pk_bf16_f32 v253, -v94, v93
    v_cvt_pk_bf16_f32 v250, v97, v98
    v_cvt_pk_bf16_f32 v254, -v98, v97
    v_cvt_pk_bf16_f32 v251, v101, v102
    v_cvt_pk_bf16_f32 v255, -v102, v101
    v_and_b32 v7, 7, v1
    v_cos_f32 v93, v92
    v_sin_f32 v94, v92
    v_cos_f32 v97, v96
    v_sin_f32 v98, v96
    v_cos_f32 v101, v100
    v_sin_f32 v102, v100
    v_lshlrev_b32 v182, 12, v7
    v_cos_f32 v109, v108
    v_sin_f32 v110, v108
    v_cos_f32 v113, v112
    v_sin_f32 v114, v112
    v_cos_f32 v117, v116
    v_sin_f32 v118, v116
    v_lshl_add_u32 v7, v7, 5, v10
    v_and_b32 v179, 0x3fff, v9
    v_mul_u32_u24 v7, 0x4100, v7
    v_lshrrev_b32 v8, 3, v1
    v_mul_f32 v91, v120, v89
    v_mul_f32 v64, v121, v90
    v_mul_f32 v95, v120, v93
    v_mul_f32 v65, v121, v94
    v_mul_f32 v99, v120, v97
    v_mul_f32 v66, v121, v98
    v_mul_f32 v103, v120, v101
    v_mul_f32 v67, v121, v102
    v_lshl_add_u32 v7, v8, 5, v7
    v_and_b32 v9, 1, v2
    v_cvt_pk_bf16_f32 v56, v105, v106
    v_cvt_pk_bf16_f32 v60, -v106, v105
    v_cvt_pk_bf16_f32 v57, v109, v110
    v_cvt_pk_bf16_f32 v61, -v110, v109
    v_cvt_pk_bf16_f32 v58, v113, v114
    v_cvt_pk_bf16_f32 v62, -v114, v113
    v_cvt_pk_bf16_f32 v59, v117, v118
    v_cvt_pk_bf16_f32 v63, -v118, v117
    v_cvt_pk_bf16_f32 v64, v91, v64
    v_cvt_pk_bf16_f32 v65, v95, v65
    v_cvt_pk_bf16_f32 v66, v99, v66
    v_cvt_pk_bf16_f32 v67, v103, v67
    v_lshl_add_u32 v181, v9, 4, v7
    v_xor_b32 v128, 0x80008000, v56
    v_xor_b32 v129, 0x80008000, v57
    v_xor_b32 v130, 0x80008000, v58
    v_xor_b32 v131, 0x80008000, v59
    v_xor_b32 v132, 0x80008000, v60
    v_xor_b32 v133, 0x80008000, v61
    v_xor_b32 v134, 0x80008000, v62
    v_xor_b32 v135, 0x80008000, v63
    v_mul_f32 v91, v120, v90
    v_mul_f32 v68, v121, v89
    v_mul_f32 v95, v120, v94
    v_mul_f32 v69, v121, v93
    v_mul_f32 v99, v120, v98
    v_mul_f32 v70, v121, v97
    v_mul_f32 v103, v120, v102
    v_mul_f32 v71, v121, v101
    v_lshlrev_b32 v9, 3, v9
    v_and_b32 v185, 3, v0
    v_accvgpr_write_b32 a128, v128
    v_accvgpr_write_b32 a129, v129
    v_accvgpr_write_b32 a130, v130
    v_accvgpr_write_b32 a131, v131
    v_accvgpr_write_b32 a132, v132
    v_accvgpr_write_b32 a133, v133
    v_accvgpr_write_b32 a134, v134
    v_accvgpr_write_b32 a135, v135
    v_cvt_pk_bf16_f32 v68, -v91, v68
    v_cvt_pk_bf16_f32 v69, -v95, v69
    v_cvt_pk_bf16_f32 v70, -v99, v70
    v_cvt_pk_bf16_f32 v71, -v103, v71
    v_and_b32 v180, 0x3fff, v180
    v_lshl_add_u32 v183, v8, 4, v9
    v_lshlrev_b32 v184, 3, v2
    v_lshlrev_b32 v185, 3, v185
    buffer_load_dwordx2 v[28:29], v50, s[8:11], s34 offen
    buffer_load_dwordx2 v[30:31], v50, s[8:11], s34 offen offset:2048
    s_add_u32 s34, s34, 0x1000
    buffer_load_dwordx2 v[32:33], v50, s[8:11], s34 offen
    buffer_load_dwordx2 v[34:35], v50, s[8:11], s34 offen offset:2048
    s_add_u32 s34, s34, 0x1000
    buffer_load_dwordx2 v[36:37], v50, s[8:11], s34 offen
    buffer_load_dwordx2 v[38:39], v50, s[8:11], s34 offen offset:2048
    s_add_u32 s34, s34, 0x1000
    buffer_load_dwordx2 v[40:41], v50, s[8:11], s34 offen
    buffer_load_dwordx2 v[42:43], v50, s[8:11], s34 offen offset:2048
    s_lshl_b32 s26, s46, 6
    s_mul_i32 s22, s3, 0x20800
    s_add_u32 s22, s22, s26
    s_add_u32 s23, s22, 0x8200
    s_add_u32 s24, s23, 0x8200
    v_cmp_gt_u32 vcc, 8, v1
    s_add_u32 s25, s24, 0x8200
    s_lshl_b32 s26, s46, 4
    s_add_u32 s26, s26, 0x1200000
    s_mul_i32 s28, s51, 0x44000
    s_lshl_b32 s27, s50, 6
    s_add_u32 s28, s28, s27
    s_add_u32 s28, s28, 0x480000
    s_add_u32 s29, s28, 0x1100
    s_add_u32 s30, s29, 0x1100
    s_add_u32 s31, s30, 0x1100
    v_mov_b32 v51, 0xcbaaa988
    v_mov_b32 v247, 0x76543210
    s_mov_b32 s32, 0x5040100
    s_mov_b32 s33, 0x7060302
    v_cndmask_b32 v51, v51, v247, vcc
    s_mul_i32 s27, s3, 0x4d00
    s_add_u32 s27, s27, 0x8000
    v_lshl_add_u32 v247, v3, 4, s27
    v_mov_b32 v128, 0
    v_mov_b32 v129, 0
    v_mov_b32 v130, 0
    v_mov_b32 v131, 0
    ds_write_b128 v247, v[128:131] offset:11520
    v_and_b32 v244, 1, v1
    v_cmp_eq_u32 vcc, 1, v244
    v_lshlrev_b32 v6, 3, v2
    v_mov_b32 v245, 0x3764
    ds_write_b128 v247, v[128:131] offset:12544
    v_mov_b32 v244, 0x2f26
    s_mov_b32 s52, 0x220
    v_sub_u32 v6, v6, v1
    v_cndmask_b32 v245, v245, v244, vcc
    s_add_u32 s53, s27, 0x3b00
    s_add_u32 s58, s27, 0x31e0
    v_lshl_add_u32 v245, v6, 1, v245
    s_add_u32 s59, s27, 0x33b0
    s_add_u32 s34, s27, 0x32f6
    ds_write_b128 v247, v[128:131] offset:13568
    v_lshlrev_b32 v6, 2, v2
    s_lshl_b32 s35, s3, 12
    s_bitcmp1_b32 s3, 0
    v_sub_u32 v6, v1, v6
    s_cselect_b32 s12, s38, s36
    s_cselect_b32 s13, s39, s37
    v_lshl_add_u32 v243, v6, 3, s58
    s_mov_b32 s14, 0x201000
    s_lshl_b32 s49, s45, 4
    s_sub_u32 s58, 0x3f2, s49
    s_bitcmp1_b32 s3, 1
    v_mov_b32 v241, s34
    s_cselect_b32 s49, s58, s49
    s_cselect_b32 s58, -1, 0
    s_cselect_b32 s34, 0x200, 0
    v_lshl_add_u32 v242, v6, 2, s59
    s_cselect_b32 s50, -1, 1
    s_lshl_b32 s50, s50, 9
    v_and_b32 v203, 56, v0
    s_lshl_b32 s59, s45, 6
    ds_write_b128 v247, v[128:131] offset:14592
    s_add_u32 s59, s59, s44
    v_add_u32 v203, s59, v203
    v_xor_b32 v203, s58, v203
    v_and_b32 v52, 7, v1
    v_subrev_u32 v203, s58, v203
    v_lshlrev_b32 v5, 2, v52
    v_lshlrev_b32 v246, 5, v1
    v_lshl_add_u32 v207, v3, 3, s44
    v_and_b32 v203, 0x7ff, v203
    v_and_b32 v7, 7, v0
    v_mul_u32_u24 v50, 0x4400, v1
    v_lshl_add_u32 v186, v3, 3, s27
    v_lshl_add_u32 v4, v2, 4, s27
    v_bfe_u32 v51, v51, v5, 4
    v_add_u32 v52, 13, v52
    v_lshl_add_u32 v246, v2, 4, v246
    v_add_u32 v245, s27, v245
    v_xor_b32 v207, s58, v207
    v_mul_u32_u24 v203, 0x402, v203
    v_min_u32 v7, 4, v7
    v_lshl_add_u32 v50, v2, 4, v50
    v_add_u32 v187, 0x880, v186
    v_add_u32 v188, 0x1100, v186
    v_add_u32 v189, 0x1980, v186
    v_add_u32 v190, 0x2200, v186
    v_mad_u32_u24 v53, v1, s52, v4
    v_mad_u32_u24 v51, v51, s52, v4
    v_mad_u32_u24 v52, v52, s52, v4
    v_add_u32 v246, s53, v246
    v_subrev_u32 v244, 0x200, v245
    v_lshlrev_b32 v208, 4, v3
    v_subrev_u32 v207, s58, v207
    v_lshl_add_u32 v203, v7, 7, v203
    s_xor_b32 s51, s45, 5
    s_or_b32 s51, s51, s3
    s_waitcnt lgkmcnt(0)
    s_add_u32 s56, s56, 1
    s_and_b32 s54, s56, 0xff
    s_mul_i32 s54, s54, 0x1010100
    s_xor_b32 s54, s54, s56
    s_mov_b32 s55, 0x10001
    v_lshrrev_b32 v184, v184, s54
    v_bfe_u32 v195, v184, 0, 2
    v_mul_u32_u24 v195, 0x8001, v195
    v_and_b32 v195, s55, v195
    v_bfe_u32 v196, v184, 2, 2
    v_mul_u32_u24 v196, 0x8001, v196
    v_and_b32 v196, s55, v196
    v_bfe_u32 v197, v184, 4, 2
    v_mul_u32_u24 v197, 0x8001, v197
    v_and_b32 v197, s55, v197
    v_bfe_u32 v198, v184, 6, 2
    v_mul_u32_u24 v198, 0x8001, v198
    v_and_b32 v198, s55, v198
    v_lshrrev_b32 v183, v183, s54
    v_bfe_u32 v191, v183, 0, 2
    v_mul_u32_u24 v191, 0x8001, v191
    v_and_b32 v191, s55, v191
    v_bfe_u32 v192, v183, 2, 2
    v_mul_u32_u24 v192, 0x8001, v192
    v_and_b32 v192, s55, v192
    v_bfe_u32 v193, v183, 4, 2
    v_mul_u32_u24 v193, 0x8001, v193
    v_and_b32 v193, s55, v193
    v_bfe_u32 v194, v183, 6, 2
    v_mul_u32_u24 v194, 0x8001, v194
    v_and_b32 v194, s55, v194
    v_lshrrev_b32 v185, v185, s54
    v_bfe_u32 v199, v185, 0, 2
    v_mul_u32_u24 v199, 0x8001, v199
    v_and_b32 v199, s55, v199
    v_bfe_u32 v200, v185, 2, 2
    v_mul_u32_u24 v200, 0x8001, v200
    v_and_b32 v200, s55, v200
    v_bfe_u32 v201, v185, 4, 2
    v_mul_u32_u24 v201, 0x8001, v201
    v_and_b32 v201, s55, v201
    v_bfe_u32 v202, v185, 6, 2
    v_mul_u32_u24 v202, 0x8001, v202
    v_and_b32 v202, s55, v202
    s_waitcnt vmcnt(18)
    v_swap_b32 v13, v16
    s_waitcnt vmcnt(17)
    v_swap_b32 v14, v20
    s_waitcnt vmcnt(16)
    v_swap_b32 v15, v24
    v_swap_b32 v18, v21
    v_swap_b32 v23, v26
    v_swap_b32 v19, v25
    v_mfma_f32_16x16x32_bf16 v[88:91], v[12:15], v[248:251], 0
    v_mfma_f32_16x16x32_bf16 v[92:95], v[12:15], v[252:255], 0
    v_mfma_f32_16x16x32_bf16 v[104:107], v[20:23], v[248:251], 0
    v_mfma_f32_16x16x32_bf16 v[108:111], v[20:23], v[252:255], 0
    v_mfma_f32_16x16x32_bf16 v[100:103], v[16:19], v[252:255], 0
    v_mfma_f32_16x16x32_bf16 v[116:119], v[24:27], v[252:255], 0
    v_mfma_f32_16x16x32_bf16 v[96:99], v[16:19], v[248:251], 0
    v_mfma_f32_16x16x32_bf16 v[112:115], v[24:27], v[248:251], 0
    s_nop 0
    v_pk_mul_f32 v[128:129], v[88:89], v[72:73] op_sel:[0,0] op_sel_hi:[1,0]
    v_pk_mul_f32 v[130:131], v[92:93], v[72:73] op_sel:[0,0] op_sel_hi:[1,0]
    v_pk_mul_f32 v[132:133], v[90:91], v[80:81] op_sel:[0,0] op_sel_hi:[1,0]
    v_pk_mul_f32 v[134:135], v[94:95], v[80:81] op_sel:[0,0] op_sel_hi:[1,0]
    v_pk_mul_f32 v[144:145], v[104:105], v[76:77] op_sel:[0,0] op_sel_hi:[1,0]
    v_pk_mul_f32 v[146:147], v[108:109], v[76:77] op_sel:[0,0] op_sel_hi:[1,0]
    v_pk_mul_f32 v[148:149], v[106:107], v[84:85] op_sel:[0,0] op_sel_hi:[1,0]
    v_pk_mul_f32 v[150:151], v[110:111], v[84:85] op_sel:[0,0] op_sel_hi:[1,0]
    v_pk_fma_f32 v[128:129], v[72:73], v[92:93], v[128:129] op_sel:[1,0,0] op_sel_hi:[1,1,1]
    v_pk_fma_f32 v[130:131], v[72:73], v[88:89], v[130:131] op_sel:[1,0,0] op_sel_hi:[1,1,1] neg_lo:[0,1,0] neg_hi:[0,1,0]
    v_pk_fma_f32 v[132:133], v[80:81], v[94:95], v[132:133] op_sel:[1,0,0] op_sel_hi:[1,1,1]
    v_pk_fma_f32 v[134:135], v[80:81], v[90:91], v[134:135] op_sel:[1,0,0] op_sel_hi:[1,1,1] neg_lo:[0,1,0] neg_hi:[0,1,0]
    v_pk_fma_f32 v[144:145], v[76:77], v[108:109], v[144:145] op_sel:[1,0,0] op_sel_hi:[1,1,1]
    v_pk_fma_f32 v[146:147], v[76:77], v[104:105], v[146:147] op_sel:[1,0,0] op_sel_hi:[1,1,1] neg_lo:[0,1,0] neg_hi:[0,1,0]
    v_pk_fma_f32 v[148:149], v[84:85], v[110:111], v[148:149] op_sel:[1,0,0] op_sel_hi:[1,1,1]
    v_pk_fma_f32 v[150:151], v[84:85], v[106:107], v[150:151] op_sel:[1,0,0] op_sel_hi:[1,1,1] neg_lo:[0,1,0] neg_hi:[0,1,0]
    v_cvt_pk_bf16_f32 v160, v128, v130
    v_cvt_pk_bf16_f32 v168, v129, v131
    v_cvt_pk_bf16_f32 v162, v132, v134
    v_cvt_pk_bf16_f32 v170, v133, v135
    v_cvt_pk_bf16_f32 v161, v144, v146
    v_cvt_pk_bf16_f32 v169, v145, v147
    v_cvt_pk_bf16_f32 v163, v148, v150
    v_cvt_pk_bf16_f32 v171, v149, v151
    v_pk_mul_f32 v[138:139], v[100:101], v[74:75] op_sel:[0,0] op_sel_hi:[1,0]
    v_pk_mul_f32 v[142:143], v[102:103], v[82:83] op_sel:[0,0] op_sel_hi:[1,0]
    v_pk_mul_f32 v[154:155], v[116:117], v[78:79] op_sel:[0,0] op_sel_hi:[1,0]
    v_pk_mul_f32 v[158:159], v[118:119], v[86:87] op_sel:[0,0] op_sel_hi:[1,0]
    v_pk_mul_f32 v[136:137], v[96:97], v[74:75] op_sel:[0,0] op_sel_hi:[1,0]
    v_pk_mul_f32 v[140:141], v[98:99], v[82:83] op_sel:[0,0] op_sel_hi:[1,0]
    v_pk_mul_f32 v[152:153], v[112:113], v[78:79] op_sel:[0,0] op_sel_hi:[1,0]
    v_pk_mul_f32 v[156:157], v[114:115], v[86:87] op_sel:[0,0] op_sel_hi:[1,0]
    v_pk_fma_f32 v[138:139], v[74:75], v[96:97], v[138:139] op_sel:[1,0,0] op_sel_hi:[1,1,1] neg_lo:[0,1,0] neg_hi:[0,1,0]
    v_pk_fma_f32 v[142:143], v[82:83], v[98:99], v[142:143] op_sel:[1,0,0] op_sel_hi:[1,1,1] neg_lo:[0,1,0] neg_hi:[0,1,0]
    v_pk_fma_f32 v[154:155], v[78:79], v[112:113], v[154:155] op_sel:[1,0,0] op_sel_hi:[1,1,1] neg_lo:[0,1,0] neg_hi:[0,1,0]
    v_pk_fma_f32 v[158:159], v[86:87], v[114:115], v[158:159] op_sel:[1,0,0] op_sel_hi:[1,1,1] neg_lo:[0,1,0] neg_hi:[0,1,0]
    v_pk_fma_f32 v[136:137], v[74:75], v[100:101], v[136:137] op_sel:[1,0,0] op_sel_hi:[1,1,1]
    v_pk_fma_f32 v[140:141], v[82:83], v[102:103], v[140:141] op_sel:[1,0,0] op_sel_hi:[1,1,1]
    v_pk_fma_f32 v[152:153], v[78:79], v[116:117], v[152:153] op_sel:[1,0,0] op_sel_hi:[1,1,1]
    v_pk_fma_f32 v[156:157], v[86:87], v[118:119], v[156:157] op_sel:[1,0,0] op_sel_hi:[1,1,1]
    v_mfma_f32_16x16x32_bf16 v[88:91], v[248:251], v[160:163], 0
    v_cvt_pk_bf16_f32 v164, v136, v138
    v_cvt_pk_bf16_f32 v172, v137, v139
    v_mfma_f32_16x16x32_bf16 v[96:99], v[252:255], v[160:163], 0
    v_cvt_pk_bf16_f32 v166, v140, v142
    v_cvt_pk_bf16_f32 v174, v141, v143
    v_mfma_f32_16x16x32_bf16 v[104:107], v[248:251], v[168:171], 0
    v_cvt_pk_bf16_f32 v165, v152, v154
    v_cvt_pk_bf16_f32 v173, v153, v155
    v_mfma_f32_16x16x32_bf16 v[112:115], v[252:255], v[168:171], 0
    v_cvt_pk_bf16_f32 v167, v156, v158
    v_cvt_pk_bf16_f32 v175, v157, v159
    s_nop 0
    v_mfma_f32_16x16x32_bf16 v[92:95], a[128:131], v[164:167], v[88:91]
    v_mfma_f32_16x16x32_bf16 v[100:103], a[132:135], v[164:167], v[96:99]
    v_mfma_f32_16x16x32_bf16 v[108:111], a[128:131], v[172:175], v[104:107]
    v_mfma_f32_16x16x32_bf16 v[116:119], a[132:135], v[172:175], v[112:115]
    s_nop 5
    v_cvt_pk_bf16_f32 v136, v92, v100
    v_cvt_pk_bf16_f32 v138, v93, v101
    v_mfma_f32_16x16x32_bf16 v[88:91], v[56:59], v[164:167], v[88:91]
    v_cvt_pk_bf16_f32 v140, v94, v102
    v_cvt_pk_bf16_f32 v142, v95, v103
    v_mfma_f32_16x16x32_bf16 v[96:99], v[60:63], v[164:167], v[96:99]
    v_cvt_pk_bf16_f32 v137, v108, v116
    ds_write_b64 v54, v[136:137] offset:8192
    v_cvt_pk_bf16_f32 v139, v109, v117
    ds_write_b64 v54, v[138:139] offset:8704
    v_mfma_f32_16x16x32_bf16 v[104:107], v[56:59], v[172:175], v[104:107]
    v_cvt_pk_bf16_f32 v141, v110, v118
    ds_write_b64 v54, v[140:141] offset:9216
    v_mfma_f32_16x16x32_bf16 v[112:115], v[60:63], v[172:175], v[112:115]
    v_cvt_pk_bf16_f32 v143, v111, v119
    ds_write_b64 v54, v[142:143] offset:9728
    v_cvt_pk_bf16_f32 v128, v88, v96
    v_cvt_pk_bf16_f32 v130, v89, v97
    v_cvt_pk_bf16_f32 v132, v90, v98
    s_nop 2
    v_cvt_pk_bf16_f32 v129, v104, v112
    ds_write_b64 v54, v[128:129] offset:0
    v_cvt_pk_bf16_f32 v131, v105, v113
    ds_write_b64 v54, v[130:131] offset:512
    v_cvt_pk_bf16_f32 v133, v106, v114
    ds_write_b64 v54, v[132:133] offset:1024
    v_cvt_pk_bf16_f32 v134, v91, v99
    v_cvt_pk_bf16_f32 v135, v107, v115
    ds_write_b64 v54, v[134:135] offset:1536
    s_waitcnt vmcnt(6)
    v_perm_b32 v220, v30, v28, s32
    s_waitcnt vmcnt(4)
    v_perm_b32 v221, v34, v32, s32
    s_waitcnt vmcnt(2)
    v_perm_b32 v222, v38, v36, s32
    s_waitcnt vmcnt(0)
    v_perm_b32 v223, v42, v40, s32
    v_bfi_b32 v220, s55, v195, v220
    v_bfi_b32 v221, s55, v196, v221
    v_bfi_b32 v222, s55, v197, v222
    v_bfi_b32 v223, s55, v198, v223
    buffer_store_dwordx4 v[220:223], v50, s[4:7], s28 offen sc1
    v_perm_b32 v224, v30, v28, s33
    v_perm_b32 v225, v34, v32, s33
    v_perm_b32 v226, v38, v36, s33
    v_perm_b32 v227, v42, v40, s33
    v_bfi_b32 v224, s55, v195, v224
    v_bfi_b32 v225, s55, v196, v225
    v_bfi_b32 v226, s55, v197, v226
    v_bfi_b32 v227, s55, v198, v227
    buffer_store_dwordx4 v[224:227], v50, s[4:7], s29 offen sc1
    v_perm_b32 v228, v31, v29, s32
    v_perm_b32 v229, v35, v33, s32
    v_perm_b32 v230, v39, v37, s32
    v_perm_b32 v231, v43, v41, s32
    v_bfi_b32 v228, s55, v195, v228
    v_bfi_b32 v229, s55, v196, v229
    v_bfi_b32 v230, s55, v197, v230
    v_bfi_b32 v231, s55, v198, v231
    buffer_store_dwordx4 v[228:231], v50, s[4:7], s30 offen sc1
    v_perm_b32 v232, v31, v29, s33
    v_perm_b32 v233, v35, v33, s33
    v_perm_b32 v234, v39, v37, s33
    v_perm_b32 v235, v43, v41, s33
    v_bfi_b32 v232, s55, v195, v232
    v_bfi_b32 v233, s55, v196, v233
    v_bfi_b32 v234, s55, v197, v234
    v_bfi_b32 v235, s55, v198, v235
    buffer_store_dwordx4 v[232:235], v50, s[4:7], s31 offen sc1
    s_waitcnt lgkmcnt(0)
    s_barrier
    s_cmp_eq_u32 s3, 3
    s_cbranch_scc0 k_no16
    ds_read_b128 v[128:131], v180
    s_waitcnt lgkmcnt(0)
    v_mfma_f32_16x16x32_bf16 v[120:123], v[128:131], v[64:67], 0
    v_mfma_f32_16x16x32_bf16 v[124:127], v[128:131], v[68:71], 0
    s_waitcnt vmcnt(4)
    v_lshl_or_b32 v149, v49, 16, v48
    v_mov_b32 v150, s56
    v_mov_b32 v151, s56
    s_nop 3
    v_cvt_pk_bf16_f32 v148, v120, v124
    s_mov_b64 exec, 0xff00
    buffer_store_dwordx4 v[148:151], v182, s[4:7], s26 offen sc1
    s_mov_b64 exec, -1
k_no16:
    ds_read_b128 v[160:163], v176
    ds_read_b128 v[164:167], v177
    ds_read_b128 v[168:171], v178
    ds_read_b128 v[172:175], v179
    s_waitcnt lgkmcnt(3)
    v_mfma_f32_16x16x32_bf16 v[88:91], v[160:163], v[64:67], 0
    v_mfma_f32_16x16x32_bf16 v[92:95], v[160:163], v[68:71], 0
    s_waitcnt lgkmcnt(2)
    v_mfma_f32_16x16x32_bf16 v[96:99], v[164:167], v[64:67], 0
    v_mfma_f32_16x16x32_bf16 v[100:103], v[164:167], v[68:71], 0
    s_nop 4
    v_cvt_pk_bf16_f32 v28, v88, v92
    s_waitcnt lgkmcnt(1)
    v_mfma_f32_16x16x32_bf16 v[104:107], v[168:171], v[64:67], 0
    v_cvt_pk_bf16_f32 v29, v89, v93
    v_cvt_pk_bf16_f32 v30, v90, v94
    v_mfma_f32_16x16x32_bf16 v[108:111], v[168:171], v[68:71], 0
    v_cvt_pk_bf16_f32 v31, v91, v95
    v_cvt_pk_bf16_f32 v32, v96, v100
    s_waitcnt lgkmcnt(0)
    v_mfma_f32_16x16x32_bf16 v[112:115], v[172:175], v[64:67], 0
    v_cvt_pk_bf16_f32 v33, v97, v101
    v_cvt_pk_bf16_f32 v34, v98, v102
    v_mfma_f32_16x16x32_bf16 v[116:119], v[172:175], v[68:71], 0
    v_cvt_pk_bf16_f32 v35, v99, v103
    v_cvt_pk_bf16_f32 v36, v104, v108
    v_cvt_pk_bf16_f32 v37, v105, v109
    v_cvt_pk_bf16_f32 v38, v106, v110
    v_cvt_pk_bf16_f32 v39, v107, v111
    v_bfi_b32 v28, s55, v191, v28
    v_bfi_b32 v29, s55, v192, v29
    v_bfi_b32 v30, s55, v193, v30
    v_bfi_b32 v31, s55, v194, v31
    v_cvt_pk_bf16_f32 v40, v112, v116
    v_cvt_pk_bf16_f32 v41, v113, v117
    v_cvt_pk_bf16_f32 v42, v114, v118
    v_cvt_pk_bf16_f32 v43, v115, v119
    v_bfi_b32 v32, s55, v191, v32
    v_bfi_b32 v33, s55, v192, v33
    v_bfi_b32 v34, s55, v193, v34
    v_bfi_b32 v35, s55, v194, v35
    v_bfi_b32 v36, s55, v191, v36
    v_bfi_b32 v37, s55, v192, v37
    v_bfi_b32 v38, s55, v193, v38
    v_bfi_b32 v39, s55, v194, v39
    v_bfi_b32 v40, s55, v191, v40
    v_bfi_b32 v41, s55, v192, v41
    v_bfi_b32 v42, s55, v193, v42
    v_bfi_b32 v43, s55, v194, v43
    s_mul_i32 s26, s48, 0x1100
    s_add_u32 s26, s26, 0x480000
    buffer_store_dwordx4 v[28:31], v181, s[4:7], s22 offen sc1
    s_and_b32 s58, s48, 1
    s_xor_b32 s58, s58, 1
    s_lshl_b32 s58, s58, 4
    v_mov_b32 v10, 0x3fb8aa3b
    s_lshl_b32 s40, s40, s58
    s_and_b32 s40, s40, 0xffff0000
    v_mul_f32 v10, s40, v10
    v_lshlrev_b32 v74, 16, v44
    v_and_b32 v75, 0xffff0000, v44
    v_exp_f32 v10, v10
    v_mul_f32 v74, 0x3fb8aa3b, v74
    v_mul_f32 v75, 0x3fb8aa3b, v75
    v_exp_f32 v74, v74
    v_exp_f32 v75, v75
    v_cvt_pk_bf16_f32 v10, v10, v10
    v_lshlrev_b32 v10, 16, v10
    v_lshlrev_b32 v76, 16, v45
    v_and_b32 v77, 0xffff0000, v45
    v_cvt_pk_bf16_f32 v70, v74, v75
    v_mul_f32 v76, v76, v10
    v_mul_f32 v77, v77, v10
    v_lshlrev_b32 v74, 16, v70
    v_and_b32 v75, 0xffff0000, v70
    v_mul_f32 v76, 0x3e22f983, v76
    v_mul_f32 v77, 0x3e22f983, v77
    v_mul_f32 v74, v74, v10
    v_mul_f32 v75, v75, v10
    v_mul_f32 v74, 0xbfb8aa3b, v74
    v_mul_f32 v75, 0xbfb8aa3b, v75
    v_fract_f32 v82, v76
    v_fract_f32 v86, v77
    v_exp_f32 v80, v74
    v_cos_f32 v54, v82
    v_sin_f32 v55, v82
    v_exp_f32 v84, v75
    buffer_store_dwordx4 v[32:35], v181, s[4:7], s23 offen sc1
    v_cos_f32 v56, v86
    v_sin_f32 v57, v86
    v_pk_mul_f32 v[54:55], v[54:55], v[80:81] op_sel:[0,0] op_sel_hi:[1,0]
    v_pk_mul_f32 v[56:57], v[56:57], v[84:85] op_sel:[0,0] op_sel_hi:[1,0]
    v_mul_f32 v94, 0x41000000, v77
    v_mov_b32 v108, 0x3f80
    v_mov_b32 v109, 0x3f80
    v_cvt_pk_bf16_f32 v110, v54, v55
    v_cvt_pk_bf16_f32 v111, v56, v57
    v_mul_f32 v92, 0x41000000, v75
    v_fract_f32 v94, v94
    ds_write2_b64 v186, v[108:109], v[110:111] offset0:0 offset1:68
    v_exp_f32 v92, v92
    v_cos_f32 v60, v94
    v_sin_f32 v61, v94
    v_pk_mul_f32 v[124:125], v[54:55], v[54:55] op_sel:[0,0] op_sel_hi:[1,0]
    v_pk_mul_f32 v[126:127], v[56:57], v[56:57] op_sel:[0,0] op_sel_hi:[1,0]
    v_pk_fma_f32 v[80:81], v[54:55], v[54:55], v[124:125] op_sel:[1,1,0] op_sel_hi:[0,1,1] neg_lo:[1,0,0]
    v_pk_fma_f32 v[82:83], v[56:57], v[56:57], v[126:127] op_sel:[1,1,0] op_sel_hi:[0,1,1] neg_lo:[1,0,0]
    v_pk_mul_f32 v[60:61], v[60:61], v[92:93] op_sel:[0,0] op_sel_hi:[1,0]
    v_pk_mul_f32 v[128:129], v[80:81], v[54:55] op_sel:[0,0] op_sel_hi:[1,0]
    v_pk_mul_f32 v[130:131], v[82:83], v[56:57] op_sel:[0,0] op_sel_hi:[1,0]
    v_pk_fma_f32 v[92:93], v[80:81], v[54:55], v[128:129] op_sel:[1,1,0] op_sel_hi:[0,1,1] neg_lo:[1,0,0]
    v_pk_fma_f32 v[94:95], v[82:83], v[56:57], v[130:131] op_sel:[1,1,0] op_sel_hi:[0,1,1] neg_lo:[1,0,0]
    v_cvt_pk_bf16_f32 v112, v80, v81
    v_cvt_pk_bf16_f32 v113, v82, v83
    v_cvt_pk_bf16_f32 v114, v92, v93
    v_cvt_pk_bf16_f32 v115, v94, v95
    ds_write2_b64 v186, v[112:113], v[114:115] offset0:136 offset1:204
    buffer_store_dwordx4 v[36:39], v181, s[4:7], s24 offen sc1
    v_pk_mul_f32 v[132:133], v[80:81], v[80:81] op_sel:[0,0] op_sel_hi:[1,0]
    v_pk_mul_f32 v[134:135], v[82:83], v[82:83] op_sel:[0,0] op_sel_hi:[1,0]
    v_pk_fma_f32 v[84:85], v[80:81], v[80:81], v[132:133] op_sel:[1,1,0] op_sel_hi:[0,1,1] neg_lo:[1,0,0]
    v_pk_fma_f32 v[86:87], v[82:83], v[82:83], v[134:135] op_sel:[1,1,0] op_sel_hi:[0,1,1] neg_lo:[1,0,0]
    v_mul_f32 v90, 0x41000000, v76
    v_pk_mul_f32 v[136:137], v[84:85], v[54:55] op_sel:[0,0] op_sel_hi:[1,0]
    v_pk_mul_f32 v[138:139], v[86:87], v[56:57] op_sel:[0,0] op_sel_hi:[1,0]
    v_mul_f32 v88, 0x41000000, v74
    v_fract_f32 v90, v90
    v_pk_fma_f32 v[104:105], v[84:85], v[54:55], v[136:137] op_sel:[1,1,0] op_sel_hi:[0,1,1] neg_lo:[1,0,0]
    v_pk_fma_f32 v[106:107], v[86:87], v[56:57], v[138:139] op_sel:[1,1,0] op_sel_hi:[0,1,1] neg_lo:[1,0,0]
    v_exp_f32 v88, v88
    v_cos_f32 v58, v90
    v_sin_f32 v59, v90
    v_cvt_pk_bf16_f32 v116, v84, v85
    v_cvt_pk_bf16_f32 v117, v86, v87
    v_cvt_pk_bf16_f32 v118, v104, v105
    v_cvt_pk_bf16_f32 v119, v106, v107
    ds_write2_b64 v187, v[116:117], v[118:119] offset0:0 offset1:68
    v_pk_mul_f32 v[58:59], v[58:59], v[88:89] op_sel:[0,0] op_sel_hi:[1,0]
    v_pk_mul_f32 v[124:125], v[84:85], v[80:81] op_sel:[0,0] op_sel_hi:[1,0]
    v_pk_mul_f32 v[126:127], v[86:87], v[82:83] op_sel:[0,0] op_sel_hi:[1,0]
    v_pk_fma_f32 v[88:89], v[84:85], v[80:81], v[124:125] op_sel:[1,1,0] op_sel_hi:[0,1,1] neg_lo:[1,0,0]
    v_pk_fma_f32 v[90:91], v[86:87], v[82:83], v[126:127] op_sel:[1,1,0] op_sel_hi:[0,1,1] neg_lo:[1,0,0]
    v_pk_mul_f32 v[128:129], v[88:89], v[54:55] op_sel:[0,0] op_sel_hi:[1,0]
    v_pk_mul_f32 v[130:131], v[90:91], v[56:57] op_sel:[0,0] op_sel_hi:[1,0]
    v_mul_f32 v98, 0x43800000, v76
    v_mul_f32 v102, 0x43800000, v77
    v_pk_fma_f32 v[92:93], v[88:89], v[54:55], v[128:129] op_sel:[1,1,0] op_sel_hi:[0,1,1] neg_lo:[1,0,0]
    v_pk_fma_f32 v[94:95], v[90:91], v[56:57], v[130:131] op_sel:[1,1,0] op_sel_hi:[0,1,1] neg_lo:[1,0,0]
    v_mul_f32 v96, 0x43800000, v74
    buffer_store_dwordx4 v[40:43], v181, s[4:7], s25 offen sc1
    v_fract_f32 v98, v98
    v_mul_f32 v100, 0x43800000, v75
    v_fract_f32 v102, v102
    v_cvt_pk_bf16_f32 v120, v88, v89
    v_cvt_pk_bf16_f32 v121, v90, v91
    v_cvt_pk_bf16_f32 v122, v92, v93
    v_cvt_pk_bf16_f32 v123, v94, v95
    v_exp_f32 v96, v96
    v_cos_f32 v62, v98
    v_sin_f32 v63, v98
    v_exp_f32 v100, v100
    v_cos_f32 v64, v102
    v_sin_f32 v65, v102
    ds_write2_b64 v187, v[120:121], v[122:123] offset0:136 offset1:204
    v_pk_mul_f32 v[62:63], v[62:63], v[96:97] op_sel:[0,0] op_sel_hi:[1,0]
    v_pk_mul_f32 v[64:65], v[64:65], v[100:101] op_sel:[0,0] op_sel_hi:[1,0]
    v_pk_mul_f32 v[132:133], v[62:63], v[80:81] op_sel:[0,0] op_sel_hi:[1,0]
    v_pk_mul_f32 v[134:135], v[64:65], v[82:83] op_sel:[0,0] op_sel_hi:[1,0]
    v_pk_fma_f32 v[104:105], v[62:63], v[80:81], v[132:133] op_sel:[1,1,0] op_sel_hi:[0,1,1] neg_lo:[1,0,0]
    v_pk_fma_f32 v[106:107], v[64:65], v[82:83], v[134:135] op_sel:[1,1,0] op_sel_hi:[0,1,1] neg_lo:[1,0,0]
    v_cvt_pk_bf16_f32 v108, v62, v63
    v_cvt_pk_bf16_f32 v109, v64, v65
    v_cvt_pk_bf16_f32 v110, v104, v105
    v_cvt_pk_bf16_f32 v111, v106, v107
    ds_write2_b64 v188, v[108:109], v[110:111] offset0:0 offset1:68
    v_pk_mul_f32 v[136:137], v[62:63], v[84:85] op_sel:[0,0] op_sel_hi:[1,0]
    v_pk_mul_f32 v[138:139], v[64:65], v[86:87] op_sel:[0,0] op_sel_hi:[1,0]
    v_pk_mul_f32 v[124:125], v[62:63], v[88:89] op_sel:[0,0] op_sel_hi:[1,0]
    v_pk_mul_f32 v[126:127], v[64:65], v[90:91] op_sel:[0,0] op_sel_hi:[1,0]
    v_pk_fma_f32 v[96:97], v[62:63], v[84:85], v[136:137] op_sel:[1,1,0] op_sel_hi:[0,1,1] neg_lo:[1,0,0]
    v_pk_fma_f32 v[98:99], v[64:65], v[86:87], v[138:139] op_sel:[1,1,0] op_sel_hi:[0,1,1] neg_lo:[1,0,0]
    v_pk_fma_f32 v[92:93], v[62:63], v[88:89], v[124:125] op_sel:[1,1,0] op_sel_hi:[0,1,1] neg_lo:[1,0,0]
    v_pk_fma_f32 v[94:95], v[64:65], v[90:91], v[126:127] op_sel:[1,1,0] op_sel_hi:[0,1,1] neg_lo:[1,0,0]
    v_cvt_pk_bf16_f32 v112, v96, v97
    v_cvt_pk_bf16_f32 v113, v98, v99
    v_cvt_pk_bf16_f32 v114, v92, v93
    v_cvt_pk_bf16_f32 v115, v94, v95
    ds_write2_b64 v188, v[112:113], v[114:115] offset0:136 offset1:204
    v_pk_mul_f32 v[128:129], v[62:63], v[58:59] op_sel:[0,0] op_sel_hi:[1,0]
    v_pk_mul_f32 v[130:131], v[64:65], v[60:61] op_sel:[0,0] op_sel_hi:[1,0]
    v_pk_mul_f32 v[132:133], v[96:97], v[62:63] op_sel:[0,0] op_sel_hi:[1,0]
    v_pk_mul_f32 v[134:135], v[98:99], v[64:65] op_sel:[0,0] op_sel_hi:[1,0]
    v_pk_fma_f32 v[100:101], v[62:63], v[58:59], v[128:129] op_sel:[1,1,0] op_sel_hi:[0,1,1] neg_lo:[1,0,0]
    v_pk_fma_f32 v[102:103], v[64:65], v[60:61], v[130:131] op_sel:[1,1,0] op_sel_hi:[0,1,1] neg_lo:[1,0,0]
    v_pk_fma_f32 v[96:97], v[96:97], v[62:63], v[132:133] op_sel:[1,1,0] op_sel_hi:[0,1,1] neg_lo:[1,0,0]
    v_pk_fma_f32 v[98:99], v[98:99], v[64:65], v[134:135] op_sel:[1,1,0] op_sel_hi:[0,1,1] neg_lo:[1,0,0]
    v_cvt_pk_bf16_f32 v116, v100, v101
    v_cvt_pk_bf16_f32 v117, v102, v103
    v_cvt_pk_bf16_f32 v118, v96, v97
    v_cvt_pk_bf16_f32 v119, v98, v99
    ds_write2_b64 v189, v[116:117], v[118:119] offset0:0 offset1:68
    v_pk_mul_f32 v[136:137], v[100:101], v[62:63] op_sel:[0,0] op_sel_hi:[1,0]
    v_pk_mul_f32 v[138:139], v[102:103], v[64:65] op_sel:[0,0] op_sel_hi:[1,0]
    v_pk_mul_f32 v[124:125], v[96:97], v[62:63] op_sel:[0,0] op_sel_hi:[1,0]
    v_pk_mul_f32 v[126:127], v[98:99], v[64:65] op_sel:[0,0] op_sel_hi:[1,0]
    v_pk_fma_f32 v[100:101], v[100:101], v[62:63], v[136:137] op_sel:[1,1,0] op_sel_hi:[0,1,1] neg_lo:[1,0,0]
    v_pk_fma_f32 v[102:103], v[102:103], v[64:65], v[138:139] op_sel:[1,1,0] op_sel_hi:[0,1,1] neg_lo:[1,0,0]
    v_pk_fma_f32 v[104:105], v[96:97], v[62:63], v[124:125] op_sel:[1,1,0] op_sel_hi:[0,1,1] neg_lo:[1,0,0]
    v_pk_fma_f32 v[106:107], v[98:99], v[64:65], v[126:127] op_sel:[1,1,0] op_sel_hi:[0,1,1] neg_lo:[1,0,0]
    v_cvt_pk_bf16_f32 v120, v100, v101
    v_cvt_pk_bf16_f32 v121, v102, v103
    v_cvt_pk_bf16_f32 v122, v104, v105
    v_cvt_pk_bf16_f32 v123, v106, v107
    ds_write2_b64 v189, v[120:121], v[122:123] offset0:136 offset1:204
    v_pk_mul_f32 v[128:129], v[100:101], v[62:63] op_sel:[0,0] op_sel_hi:[1,0]
    v_pk_mul_f32 v[130:131], v[102:103], v[64:65] op_sel:[0,0] op_sel_hi:[1,0]
    v_pk_mul_f32 v[132:133], v[96:97], v[96:97] op_sel:[0,0] op_sel_hi:[1,0]
    v_pk_mul_f32 v[134:135], v[98:99], v[98:99] op_sel:[0,0] op_sel_hi:[1,0]
    v_pk_fma_f32 v[100:101], v[100:101], v[62:63], v[128:129] op_sel:[1,1,0] op_sel_hi:[0,1,1] neg_lo:[1,0,0]
    v_pk_fma_f32 v[102:103], v[102:103], v[64:65], v[130:131] op_sel:[1,1,0] op_sel_hi:[0,1,1] neg_lo:[1,0,0]
    v_pk_fma_f32 v[92:93], v[96:97], v[96:97], v[132:133] op_sel:[1,1,0] op_sel_hi:[0,1,1] neg_lo:[1,0,0]
    v_pk_fma_f32 v[94:95], v[98:99], v[98:99], v[134:135] op_sel:[1,1,0] op_sel_hi:[0,1,1] neg_lo:[1,0,0]
    v_cvt_pk_bf16_f32 v108, v100, v101
    v_cvt_pk_bf16_f32 v109, v102, v103
    v_cvt_pk_bf16_f32 v110, v92, v93
    v_cvt_pk_bf16_f32 v111, v94, v95
    ds_write2_b64 v190, v[108:109], v[110:111] offset0:0 offset1:68
    v_pk_mul_f32 v[136:137], v[92:93], v[62:63] op_sel:[0,0] op_sel_hi:[1,0]
    v_pk_mul_f32 v[138:139], v[94:95], v[64:65] op_sel:[0,0] op_sel_hi:[1,0]
    v_pk_fma_f32 v[92:93], v[92:93], v[62:63], v[136:137] op_sel:[1,1,0] op_sel_hi:[0,1,1] neg_lo:[1,0,0]
    v_pk_fma_f32 v[94:95], v[94:95], v[64:65], v[138:139] op_sel:[1,1,0] op_sel_hi:[0,1,1] neg_lo:[1,0,0]
    v_cvt_pk_bf16_f32 v112, v92, v93
    v_cvt_pk_bf16_f32 v113, v94, v95
    v_pk_mul_f32 v[124:125], v[92:93], v[62:63] op_sel:[0,0] op_sel_hi:[1,0]
    v_pk_mul_f32 v[126:127], v[94:95], v[64:65] op_sel:[0,0] op_sel_hi:[1,0]
    v_pk_fma_f32 v[92:93], v[92:93], v[62:63], v[124:125] op_sel:[1,1,0] op_sel_hi:[0,1,1] neg_lo:[1,0,0]
    v_pk_fma_f32 v[94:95], v[94:95], v[64:65], v[126:127] op_sel:[1,1,0] op_sel_hi:[0,1,1] neg_lo:[1,0,0]
    v_cvt_pk_bf16_f32 v114, v92, v93
    v_cvt_pk_bf16_f32 v115, v94, v95
    ds_write2_b64 v190, v[112:113], v[114:115] offset0:136 offset1:204
    v_pk_mul_f32 v[128:129], v[92:93], v[62:63] op_sel:[0,0] op_sel_hi:[1,0]
    v_pk_mul_f32 v[130:131], v[94:95], v[64:65] op_sel:[0,0] op_sel_hi:[1,0]
    v_pk_fma_f32 v[92:93], v[92:93], v[62:63], v[128:129] op_sel:[1,1,0] op_sel_hi:[0,1,1] neg_lo:[1,0,0]
    v_pk_fma_f32 v[94:95], v[94:95], v[64:65], v[130:131] op_sel:[1,1,0] op_sel_hi:[0,1,1] neg_lo:[1,0,0]
    v_cvt_pk_bf16_f32 v116, v92, v93
    v_cvt_pk_bf16_f32 v117, v94, v95
    ds_write_b64 v186, v[116:117] offset:10880
    v_lshlrev_b32 v66, 16, v46
    v_lshlrev_b32 v67, 16, v47
    v_and_b32 v68, 0xffff0000, v46
    v_and_b32 v69, 0xffff0000, v47
    v_add_f32 v72, v10, v10
    v_pk_mul_f32 v[66:67], v[66:67], v[72:73] op_sel:[0,0] op_sel_hi:[1,0]
    v_pk_mul_f32 v[68:69], v[68:69], v[72:73] op_sel:[0,0] op_sel_hi:[1,0]
    s_lshl_b32 s41, s41, s58
    ds_read_b128 a[0:3], v51 offset:0
    s_and_b32 s41, s41, 0xffff0000
    ds_read_b128 a[4:7], v51 offset:64
    ds_read_b128 a[8:11], v51 offset:128
    ds_read_b128 a[12:15], v51 offset:192
    ds_read_b128 a[16:19], v51 offset:256
    ds_read_b128 a[20:23], v51 offset:320
    ds_read_b128 a[24:27], v51 offset:384
    ds_read_b128 a[28:31], v51 offset:448
    ds_read_b128 a[32:35], v52 offset:0
    ds_read_b128 a[36:39], v52 offset:64
    ds_read_b128 a[40:43], v52 offset:128
    ds_read_b128 a[44:47], v52 offset:192
    ds_read_b128 a[48:51], v52 offset:256
    ds_read_b128 a[52:55], v52 offset:320
    ds_read_b128 a[56:59], v52 offset:384
    ds_read_b128 a[60:63], v52 offset:448
    buffer_load_dword v204, v203, s[12:15], s34 offen
    v_cvt_pk_bf16_f32 v108, v66, -v67
    v_cvt_pk_bf16_f32 v109, v68, -v69
    v_pk_mul_f32 v[132:133], v[66:67], v[58:59] op_sel:[0,0] op_sel_hi:[1,0]
    v_pk_mul_f32 v[134:135], v[68:69], v[60:61] op_sel:[0,0] op_sel_hi:[1,0]
    v_pk_fma_f32 v[66:67], v[66:67], v[58:59], v[132:133] op_sel:[1,1,0] op_sel_hi:[0,1,1] neg_lo:[1,0,0]
    v_pk_fma_f32 v[68:69], v[68:69], v[60:61], v[134:135] op_sel:[1,1,0] op_sel_hi:[0,1,1] neg_lo:[1,0,0]
    v_cvt_pk_bf16_f32 v110, v66, -v67
    v_cvt_pk_bf16_f32 v111, v68, -v69
    ds_write2_b64 v186, v[108:109], v[110:111] offset0:0 offset1:68
    v_pk_mul_f32 v[136:137], v[66:67], v[58:59] op_sel:[0,0] op_sel_hi:[1,0]
    v_pk_mul_f32 v[138:139], v[68:69], v[60:61] op_sel:[0,0] op_sel_hi:[1,0]
    v_pk_fma_f32 v[66:67], v[66:67], v[58:59], v[136:137] op_sel:[1,1,0] op_sel_hi:[0,1,1] neg_lo:[1,0,0]
    v_pk_fma_f32 v[68:69], v[68:69], v[60:61], v[138:139] op_sel:[1,1,0] op_sel_hi:[0,1,1] neg_lo:[1,0,0]
    v_cvt_pk_bf16_f32 v112, v66, -v67
    v_cvt_pk_bf16_f32 v113, v68, -v69
    v_pk_mul_f32 v[124:125], v[66:67], v[58:59] op_sel:[0,0] op_sel_hi:[1,0]
    v_pk_mul_f32 v[126:127], v[68:69], v[60:61] op_sel:[0,0] op_sel_hi:[1,0]
    v_pk_fma_f32 v[66:67], v[66:67], v[58:59], v[124:125] op_sel:[1,1,0] op_sel_hi:[0,1,1] neg_lo:[1,0,0]
    v_pk_fma_f32 v[68:69], v[68:69], v[60:61], v[126:127] op_sel:[1,1,0] op_sel_hi:[0,1,1] neg_lo:[1,0,0]
    v_cvt_pk_bf16_f32 v114, v66, -v67
    v_cvt_pk_bf16_f32 v115, v68, -v69
    ds_write2_b64 v186, v[112:113], v[114:115] offset0:136 offset1:204
    v_pk_mul_f32 v[128:129], v[66:67], v[58:59] op_sel:[0,0] op_sel_hi:[1,0]
    v_pk_mul_f32 v[130:131], v[68:69], v[60:61] op_sel:[0,0] op_sel_hi:[1,0]
    v_pk_fma_f32 v[66:67], v[66:67], v[58:59], v[128:129] op_sel:[1,1,0] op_sel_hi:[0,1,1] neg_lo:[1,0,0]
    v_pk_fma_f32 v[68:69], v[68:69], v[60:61], v[130:131] op_sel:[1,1,0] op_sel_hi:[0,1,1] neg_lo:[1,0,0]
    v_cvt_pk_bf16_f32 v116, v66, -v67
    v_cvt_pk_bf16_f32 v117, v68, -v69
    v_pk_mul_f32 v[132:133], v[66:67], v[58:59] op_sel:[0,0] op_sel_hi:[1,0]
    v_pk_mul_f32 v[134:135], v[68:69], v[60:61] op_sel:[0,0] op_sel_hi:[1,0]
    v_pk_fma_f32 v[66:67], v[66:67], v[58:59], v[132:133] op_sel:[1,1,0] op_sel_hi:[0,1,1] neg_lo:[1,0,0]
    v_pk_fma_f32 v[68:69], v[68:69], v[60:61], v[134:135] op_sel:[1,1,0] op_sel_hi:[0,1,1] neg_lo:[1,0,0]
    v_cvt_pk_bf16_f32 v118, v66, -v67
    v_cvt_pk_bf16_f32 v119, v68, -v69
    ds_write2_b64 v187, v[116:117], v[118:119] offset0:0 offset1:68
    v_pk_mul_f32 v[136:137], v[66:67], v[58:59] op_sel:[0,0] op_sel_hi:[1,0]
    v_pk_mul_f32 v[138:139], v[68:69], v[60:61] op_sel:[0,0] op_sel_hi:[1,0]
    v_pk_fma_f32 v[66:67], v[66:67], v[58:59], v[136:137] op_sel:[1,1,0] op_sel_hi:[0,1,1] neg_lo:[1,0,0]
    v_pk_fma_f32 v[68:69], v[68:69], v[60:61], v[138:139] op_sel:[1,1,0] op_sel_hi:[0,1,1] neg_lo:[1,0,0]
    v_cvt_pk_bf16_f32 v120, v66, -v67
    v_cvt_pk_bf16_f32 v121, v68, -v69
    v_pk_mul_f32 v[124:125], v[66:67], v[58:59] op_sel:[0,0] op_sel_hi:[1,0]
    v_pk_mul_f32 v[126:127], v[68:69], v[60:61] op_sel:[0,0] op_sel_hi:[1,0]
    v_pk_fma_f32 v[66:67], v[66:67], v[58:59], v[124:125] op_sel:[1,1,0] op_sel_hi:[0,1,1] neg_lo:[1,0,0]
    v_pk_fma_f32 v[68:69], v[68:69], v[60:61], v[126:127] op_sel:[1,1,0] op_sel_hi:[0,1,1] neg_lo:[1,0,0]
    v_cvt_pk_bf16_f32 v122, v66, -v67
    v_cvt_pk_bf16_f32 v123, v68, -v69
    ds_write2_b64 v187, v[120:121], v[122:123] offset0:136 offset1:204
    v_pk_mul_f32 v[128:129], v[66:67], v[58:59] op_sel:[0,0] op_sel_hi:[1,0]
    v_pk_mul_f32 v[130:131], v[68:69], v[60:61] op_sel:[0,0] op_sel_hi:[1,0]
    v_pk_fma_f32 v[66:67], v[66:67], v[58:59], v[128:129] op_sel:[1,1,0] op_sel_hi:[0,1,1] neg_lo:[1,0,0]
    v_pk_fma_f32 v[68:69], v[68:69], v[60:61], v[130:131] op_sel:[1,1,0] op_sel_hi:[0,1,1] neg_lo:[1,0,0]
    v_cvt_pk_bf16_f32 v108, v66, -v67
    v_cvt_pk_bf16_f32 v109, v68, -v69
    v_pk_mul_f32 v[132:133], v[66:67], v[58:59] op_sel:[0,0] op_sel_hi:[1,0]
    v_pk_mul_f32 v[134:135], v[68:69], v[60:61] op_sel:[0,0] op_sel_hi:[1,0]
    v_pk_fma_f32 v[66:67], v[66:67], v[58:59], v[132:133] op_sel:[1,1,0] op_sel_hi:[0,1,1] neg_lo:[1,0,0]
    v_pk_fma_f32 v[68:69], v[68:69], v[60:61], v[134:135] op_sel:[1,1,0] op_sel_hi:[0,1,1] neg_lo:[1,0,0]
    v_cvt_pk_bf16_f32 v110, v66, -v67
    v_cvt_pk_bf16_f32 v111, v68, -v69
    ds_write2_b64 v188, v[108:109], v[110:111] offset0:0 offset1:68
    v_pk_mul_f32 v[136:137], v[66:67], v[58:59] op_sel:[0,0] op_sel_hi:[1,0]
    v_pk_mul_f32 v[138:139], v[68:69], v[60:61] op_sel:[0,0] op_sel_hi:[1,0]
    v_pk_fma_f32 v[66:67], v[66:67], v[58:59], v[136:137] op_sel:[1,1,0] op_sel_hi:[0,1,1] neg_lo:[1,0,0]
    v_pk_fma_f32 v[68:69], v[68:69], v[60:61], v[138:139] op_sel:[1,1,0] op_sel_hi:[0,1,1] neg_lo:[1,0,0]
    v_cvt_pk_bf16_f32 v112, v66, -v67
    v_cvt_pk_bf16_f32 v113, v68, -v69
    v_pk_mul_f32 v[124:125], v[66:67], v[58:59] op_sel:[0,0] op_sel_hi:[1,0]
    v_pk_mul_f32 v[126:127], v[68:69], v[60:61] op_sel:[0,0] op_sel_hi:[1,0]
    v_pk_fma_f32 v[66:67], v[66:67], v[58:59], v[124:125] op_sel:[1,1,0] op_sel_hi:[0,1,1] neg_lo:[1,0,0]
    v_pk_fma_f32 v[68:69], v[68:69], v[60:61], v[126:127] op_sel:[1,1,0] op_sel_hi:[0,1,1] neg_lo:[1,0,0]
    v_cvt_pk_bf16_f32 v114, v66, -v67
    v_cvt_pk_bf16_f32 v115, v68, -v69
    ds_write2_b64 v188, v[112:113], v[114:115] offset0:136 offset1:204
    v_pk_mul_f32 v[128:129], v[66:67], v[58:59] op_sel:[0,0] op_sel_hi:[1,0]
    v_pk_mul_f32 v[130:131], v[68:69], v[60:61] op_sel:[0,0] op_sel_hi:[1,0]
    v_pk_fma_f32 v[66:67], v[66:67], v[58:59], v[128:129] op_sel:[1,1,0] op_sel_hi:[0,1,1] neg_lo:[1,0,0]
    v_pk_fma_f32 v[68:69], v[68:69], v[60:61], v[130:131] op_sel:[1,1,0] op_sel_hi:[0,1,1] neg_lo:[1,0,0]
    v_cvt_pk_bf16_f32 v116, v66, -v67
    v_cvt_pk_bf16_f32 v117, v68, -v69
    v_pk_mul_f32 v[132:133], v[66:67], v[58:59] op_sel:[0,0] op_sel_hi:[1,0]
    v_pk_mul_f32 v[134:135], v[68:69], v[60:61] op_sel:[0,0] op_sel_hi:[1,0]
    v_pk_fma_f32 v[66:67], v[66:67], v[58:59], v[132:133] op_sel:[1,1,0] op_sel_hi:[0,1,1] neg_lo:[1,0,0]
    v_pk_fma_f32 v[68:69], v[68:69], v[60:61], v[134:135] op_sel:[1,1,0] op_sel_hi:[0,1,1] neg_lo:[1,0,0]
    v_cvt_pk_bf16_f32 v118, v66, -v67
    v_cvt_pk_bf16_f32 v119, v68, -v69
    ds_write2_b64 v189, v[116:117], v[118:119] offset0:0 offset1:68
    v_pk_mul_f32 v[136:137], v[66:67], v[58:59] op_sel:[0,0] op_sel_hi:[1,0]
    v_pk_mul_f32 v[138:139], v[68:69], v[60:61] op_sel:[0,0] op_sel_hi:[1,0]
    v_pk_fma_f32 v[66:67], v[66:67], v[58:59], v[136:137] op_sel:[1,1,0] op_sel_hi:[0,1,1] neg_lo:[1,0,0]
    v_pk_fma_f32 v[68:69], v[68:69], v[60:61], v[138:139] op_sel:[1,1,0] op_sel_hi:[0,1,1] neg_lo:[1,0,0]
    v_cvt_pk_bf16_f32 v120, v66, -v67
    v_cvt_pk_bf16_f32 v121, v68, -v69
    v_pk_mul_f32 v[124:125], v[66:67], v[58:59] op_sel:[0,0] op_sel_hi:[1,0]
    v_pk_mul_f32 v[126:127], v[68:69], v[60:61] op_sel:[0,0] op_sel_hi:[1,0]
    v_pk_fma_f32 v[66:67], v[66:67], v[58:59], v[124:125] op_sel:[1,1,0] op_sel_hi:[0,1,1] neg_lo:[1,0,0]
    v_pk_fma_f32 v[68:69], v[68:69], v[60:61], v[126:127] op_sel:[1,1,0] op_sel_hi:[0,1,1] neg_lo:[1,0,0]
    v_cvt_pk_bf16_f32 v122, v66, -v67
    v_cvt_pk_bf16_f32 v123, v68, -v69
    ds_write2_b64 v189, v[120:121], v[122:123] offset0:136 offset1:204
    v_pk_mul_f32 v[128:129], v[66:67], v[58:59] op_sel:[0,0] op_sel_hi:[1,0]
    v_pk_mul_f32 v[130:131], v[68:69], v[60:61] op_sel:[0,0] op_sel_hi:[1,0]
    v_pk_fma_f32 v[66:67], v[66:67], v[58:59], v[128:129] op_sel:[1,1,0] op_sel_hi:[0,1,1] neg_lo:[1,0,0]
    v_pk_fma_f32 v[68:69], v[68:69], v[60:61], v[130:131] op_sel:[1,1,0] op_sel_hi:[0,1,1] neg_lo:[1,0,0]
    v_cvt_pk_bf16_f32 v108, v66, -v67
    v_cvt_pk_bf16_f32 v109, v68, -v69
    v_pk_mul_f32 v[132:133], v[66:67], v[58:59] op_sel:[0,0] op_sel_hi:[1,0]
    v_pk_mul_f32 v[134:135], v[68:69], v[60:61] op_sel:[0,0] op_sel_hi:[1,0]
    v_pk_fma_f32 v[66:67], v[66:67], v[58:59], v[132:133] op_sel:[1,1,0] op_sel_hi:[0,1,1] neg_lo:[1,0,0]
    v_pk_fma_f32 v[68:69], v[68:69], v[60:61], v[134:135] op_sel:[1,1,0] op_sel_hi:[0,1,1] neg_lo:[1,0,0]
    ds_read_b128 a[64:67], v53 offset:0
    v_cvt_pk_bf16_f32 v110, v66, -v67
    v_cvt_pk_bf16_f32 v111, v68, -v69
    v_pk_mul_f32 v[136:137], v[66:67], v[58:59] op_sel:[0,0] op_sel_hi:[1,0]
    ds_read_b128 a[68:71], v53 offset:64
    v_pk_mul_f32 v[138:139], v[68:69], v[60:61] op_sel:[0,0] op_sel_hi:[1,0]
    v_pk_fma_f32 v[66:67], v[66:67], v[58:59], v[136:137] op_sel:[1,1,0] op_sel_hi:[0,1,1] neg_lo:[1,0,0]
    v_pk_fma_f32 v[68:69], v[68:69], v[60:61], v[138:139] op_sel:[1,1,0] op_sel_hi:[0,1,1] neg_lo:[1,0,0]
    ds_read_b128 a[72:75], v53 offset:128
    v_cvt_pk_bf16_f32 v112, v66, -v67
    v_cvt_pk_bf16_f32 v113, v68, -v69
    v_pk_mul_f32 v[124:125], v[66:67], v[58:59] op_sel:[0,0] op_sel_hi:[1,0]
    ds_read_b128 a[76:79], v53 offset:192
    v_pk_mul_f32 v[126:127], v[68:69], v[60:61] op_sel:[0,0] op_sel_hi:[1,0]
    v_pk_fma_f32 v[66:67], v[66:67], v[58:59], v[124:125] op_sel:[1,1,0] op_sel_hi:[0,1,1] neg_lo:[1,0,0]
    v_pk_fma_f32 v[68:69], v[68:69], v[60:61], v[126:127] op_sel:[1,1,0] op_sel_hi:[0,1,1] neg_lo:[1,0,0]
    ds_read_b128 a[80:83], v53 offset:256
    v_cvt_pk_bf16_f32 v114, v66, -v67
    v_cvt_pk_bf16_f32 v115, v68, -v69
    v_pk_mul_f32 v[128:129], v[66:67], v[58:59] op_sel:[0,0] op_sel_hi:[1,0]
    ds_read_b128 a[84:87], v53 offset:320
    v_pk_mul_f32 v[130:131], v[68:69], v[60:61] op_sel:[0,0] op_sel_hi:[1,0]
    v_pk_fma_f32 v[66:67], v[66:67], v[58:59], v[128:129] op_sel:[1,1,0] op_sel_hi:[0,1,1] neg_lo:[1,0,0]
    v_pk_fma_f32 v[68:69], v[68:69], v[60:61], v[130:131] op_sel:[1,1,0] op_sel_hi:[0,1,1] neg_lo:[1,0,0]
    ds_read_b128 a[88:91], v53 offset:384
    v_cvt_pk_bf16_f32 v116, v66, -v67
    v_cvt_pk_bf16_f32 v117, v68, -v69
    v_pk_mul_f32 v[132:133], v[66:67], v[58:59] op_sel:[0,0] op_sel_hi:[1,0]
    ds_read_b128 a[92:95], v53 offset:448
    v_pk_mul_f32 v[134:135], v[68:69], v[60:61] op_sel:[0,0] op_sel_hi:[1,0]
    s_waitcnt lgkmcnt(7)
    v_mfma_f32_16x16x32_bf16 v[140:143], a[0:3], a[64:67], 0
    ds_write2_b64 v186, v[108:109], v[110:111] offset0:0 offset1:68
    v_pk_fma_f32 v[66:67], v[66:67], v[58:59], v[132:133] op_sel:[1,1,0] op_sel_hi:[0,1,1] neg_lo:[1,0,0]
    v_pk_fma_f32 v[68:69], v[68:69], v[60:61], v[134:135] op_sel:[1,1,0] op_sel_hi:[0,1,1] neg_lo:[1,0,0]
    v_cvt_pk_bf16_f32 v118, v66, -v67
    v_cvt_pk_bf16_f32 v119, v68, -v69
    v_mfma_f32_16x16x32_bf16 v[144:147], a[32:35], a[64:67], 0
    ds_write2_b64 v186, v[112:113], v[114:115] offset0:136 offset1:204
    v_pk_mul_f32 v[136:137], v[66:67], v[58:59] op_sel:[0,0] op_sel_hi:[1,0]
    v_pk_mul_f32 v[138:139], v[68:69], v[60:61] op_sel:[0,0] op_sel_hi:[1,0]
    v_pk_fma_f32 v[66:67], v[66:67], v[58:59], v[136:137] op_sel:[1,1,0] op_sel_hi:[0,1,1] neg_lo:[1,0,0]
    v_pk_fma_f32 v[68:69], v[68:69], v[60:61], v[138:139] op_sel:[1,1,0] op_sel_hi:[0,1,1] neg_lo:[1,0,0]
    s_waitcnt lgkmcnt(8)
    v_mfma_f32_16x16x32_bf16 v[140:143], a[4:7], a[68:71], v[140:143]
    ds_write2_b64 v187, v[116:117], v[118:119] offset0:0 offset1:68
    v_cvt_pk_bf16_f32 v120, v66, -v67
    v_cvt_pk_bf16_f32 v121, v68, -v69
    v_pk_mul_f32 v[124:125], v[66:67], v[58:59] op_sel:[0,0] op_sel_hi:[1,0]
    v_pk_mul_f32 v[126:127], v[68:69], v[60:61] op_sel:[0,0] op_sel_hi:[1,0]
    v_pk_fma_f32 v[66:67], v[66:67], v[58:59], v[124:125] op_sel:[1,1,0] op_sel_hi:[0,1,1] neg_lo:[1,0,0]
    v_pk_fma_f32 v[68:69], v[68:69], v[60:61], v[126:127] op_sel:[1,1,0] op_sel_hi:[0,1,1] neg_lo:[1,0,0]
    v_cvt_pk_bf16_f32 v122, v66, -v67
    v_cvt_pk_bf16_f32 v123, v68, -v69
    v_mfma_f32_16x16x32_bf16 v[144:147], a[36:39], a[68:71], v[144:147]
    ds_write2_b64 v187, v[120:121], v[122:123] offset0:136 offset1:204
    v_pk_mul_f32 v[128:129], v[66:67], v[58:59] op_sel:[0,0] op_sel_hi:[1,0]
    v_pk_mul_f32 v[130:131], v[68:69], v[60:61] op_sel:[0,0] op_sel_hi:[1,0]
    v_pk_fma_f32 v[66:67], v[66:67], v[58:59], v[128:129] op_sel:[1,1,0] op_sel_hi:[0,1,1] neg_lo:[1,0,0]
    v_pk_fma_f32 v[68:69], v[68:69], v[60:61], v[130:131] op_sel:[1,1,0] op_sel_hi:[0,1,1] neg_lo:[1,0,0]
    v_cvt_pk_bf16_f32 v108, v66, -v67
    v_cvt_pk_bf16_f32 v109, v68, -v69
    v_pk_mul_f32 v[132:133], v[66:67], v[58:59] op_sel:[0,0] op_sel_hi:[1,0]
    v_pk_mul_f32 v[134:135], v[68:69], v[60:61] op_sel:[0,0] op_sel_hi:[1,0]
    v_pk_fma_f32 v[66:67], v[66:67], v[58:59], v[132:133] op_sel:[1,1,0] op_sel_hi:[0,1,1] neg_lo:[1,0,0]
    v_pk_fma_f32 v[68:69], v[68:69], v[60:61], v[134:135] op_sel:[1,1,0] op_sel_hi:[0,1,1] neg_lo:[1,0,0]
    v_cvt_pk_bf16_f32 v110, v66, -v67
    v_cvt_pk_bf16_f32 v111, v68, -v69
    s_waitcnt lgkmcnt(9)
    v_mfma_f32_16x16x32_bf16 v[140:143], a[8:11], a[72:75], v[140:143]
    ds_write2_b64 v188, v[108:109], v[110:111] offset0:0 offset1:68
    v_pk_mul_f32 v[136:137], v[66:67], v[58:59] op_sel:[0,0] op_sel_hi:[1,0]
    v_pk_mul_f32 v[138:139], v[68:69], v[60:61] op_sel:[0,0] op_sel_hi:[1,0]
    v_pk_fma_f32 v[66:67], v[66:67], v[58:59], v[136:137] op_sel:[1,1,0] op_sel_hi:[0,1,1] neg_lo:[1,0,0]
    v_pk_fma_f32 v[68:69], v[68:69], v[60:61], v[138:139] op_sel:[1,1,0] op_sel_hi:[0,1,1] neg_lo:[1,0,0]
    v_cvt_pk_bf16_f32 v112, v66, -v67
    v_cvt_pk_bf16_f32 v113, v68, -v69
    v_pk_mul_f32 v[124:125], v[66:67], v[58:59] op_sel:[0,0] op_sel_hi:[1,0]
    v_pk_mul_f32 v[126:127], v[68:69], v[60:61] op_sel:[0,0] op_sel_hi:[1,0]
    v_pk_fma_f32 v[66:67], v[66:67], v[58:59], v[124:125] op_sel:[1,1,0] op_sel_hi:[0,1,1] neg_lo:[1,0,0]
    v_pk_fma_f32 v[68:69], v[68:69], v[60:61], v[126:127] op_sel:[1,1,0] op_sel_hi:[0,1,1] neg_lo:[1,0,0]
    v_cvt_pk_bf16_f32 v114, v66, -v67
    v_cvt_pk_bf16_f32 v115, v68, -v69
    v_mfma_f32_16x16x32_bf16 v[144:147], a[40:43], a[72:75], v[144:147]
    ds_write2_b64 v188, v[112:113], v[114:115] offset0:136 offset1:204
    v_pk_mul_f32 v[128:129], v[66:67], v[58:59] op_sel:[0,0] op_sel_hi:[1,0]
    v_pk_mul_f32 v[130:131], v[68:69], v[60:61] op_sel:[0,0] op_sel_hi:[1,0]
    v_pk_fma_f32 v[66:67], v[66:67], v[58:59], v[128:129] op_sel:[1,1,0] op_sel_hi:[0,1,1] neg_lo:[1,0,0]
    v_pk_fma_f32 v[68:69], v[68:69], v[60:61], v[130:131] op_sel:[1,1,0] op_sel_hi:[0,1,1] neg_lo:[1,0,0]
    v_cvt_pk_bf16_f32 v116, v66, -v67
    v_cvt_pk_bf16_f32 v117, v68, -v69
    v_pk_mul_f32 v[132:133], v[66:67], v[58:59] op_sel:[0,0] op_sel_hi:[1,0]
    v_pk_mul_f32 v[134:135], v[68:69], v[60:61] op_sel:[0,0] op_sel_hi:[1,0]
    v_pk_fma_f32 v[66:67], v[66:67], v[58:59], v[132:133] op_sel:[1,1,0] op_sel_hi:[0,1,1] neg_lo:[1,0,0]
    v_pk_fma_f32 v[68:69], v[68:69], v[60:61], v[134:135] op_sel:[1,1,0] op_sel_hi:[0,1,1] neg_lo:[1,0,0]
    v_cvt_pk_bf16_f32 v118, v66, -v67
    v_cvt_pk_bf16_f32 v119, v68, -v69
    s_waitcnt lgkmcnt(10)
    v_mfma_f32_16x16x32_bf16 v[140:143], a[12:15], a[76:79], v[140:143]
    ds_write2_b64 v189, v[116:117], v[118:119] offset0:0 offset1:68
    v_pk_mul_f32 v[136:137], v[66:67], v[58:59] op_sel:[0,0] op_sel_hi:[1,0]
    v_pk_mul_f32 v[138:139], v[68:69], v[60:61] op_sel:[0,0] op_sel_hi:[1,0]
    v_pk_fma_f32 v[66:67], v[66:67], v[58:59], v[136:137] op_sel:[1,1,0] op_sel_hi:[0,1,1] neg_lo:[1,0,0]
    v_pk_fma_f32 v[68:69], v[68:69], v[60:61], v[138:139] op_sel:[1,1,0] op_sel_hi:[0,1,1] neg_lo:[1,0,0]
    v_cvt_pk_bf16_f32 v120, v66, -v67
    v_cvt_pk_bf16_f32 v121, v68, -v69
    v_pk_mul_f32 v[124:125], v[66:67], v[58:59] op_sel:[0,0] op_sel_hi:[1,0]
    v_pk_mul_f32 v[126:127], v[68:69], v[60:61] op_sel:[0,0] op_sel_hi:[1,0]
    v_pk_fma_f32 v[66:67], v[66:67], v[58:59], v[124:125] op_sel:[1,1,0] op_sel_hi:[0,1,1] neg_lo:[1,0,0]
    v_pk_fma_f32 v[68:69], v[68:69], v[60:61], v[126:127] op_sel:[1,1,0] op_sel_hi:[0,1,1] neg_lo:[1,0,0]
    v_mfma_f32_16x16x32_bf16 v[144:147], a[44:47], a[76:79], v[144:147]
    v_cvt_pk_bf16_f32 v122, v66, -v67
    v_cvt_pk_bf16_f32 v123, v68, -v69
    s_waitcnt lgkmcnt(10)
    v_mfma_f32_16x16x32_bf16 v[140:143], a[16:19], a[80:83], v[140:143]
    ds_write2_b64 v189, v[120:121], v[122:123] offset0:136 offset1:204
    v_mfma_f32_16x16x32_bf16 v[144:147], a[48:51], a[80:83], v[144:147]
    s_waitcnt lgkmcnt(10)
    v_mfma_f32_16x16x32_bf16 v[140:143], a[20:23], a[84:87], v[140:143]
    ds_read_b128 a[64:67], v53 offset:0
    v_mfma_f32_16x16x32_bf16 v[144:147], a[52:55], a[84:87], v[144:147]
    ds_read_b128 a[68:71], v53 offset:64
    s_waitcnt lgkmcnt(11)
    v_mfma_f32_16x16x32_bf16 v[140:143], a[24:27], a[88:91], v[140:143]
    ds_read_b128 a[72:75], v53 offset:128
    v_mfma_f32_16x16x32_bf16 v[144:147], a[56:59], a[88:91], v[144:147]
    ds_read_b128 a[76:79], v53 offset:192
    s_waitcnt lgkmcnt(12)
    v_mfma_f32_16x16x32_bf16 v[140:143], a[28:31], a[92:95], v[140:143]
    ds_read_b128 a[80:83], v53 offset:256
    v_mfma_f32_16x16x32_bf16 v[144:147], a[60:63], a[92:95], v[144:147]
    ds_read_b128 a[84:87], v53 offset:320
    ds_read_b128 a[88:91], v53 offset:384
    ds_read_b128 a[92:95], v53 offset:448
    s_add_u32 m0, s27, 0x3d00
    s_nop 0
    buffer_load_dwordx4 v208, s[4:7], s26 offen sc1 lds
    buffer_load_dwordx4 v208, s[4:7], s26 offen offset:1024 sc1 lds
    buffer_load_dwordx4 v208, s[4:7], s26 offen offset:2048 sc1 lds
    buffer_load_dwordx4 v208, s[4:7], s26 offen offset:3072 sc1 lds
    s_waitcnt lgkmcnt(7)
    v_mfma_f32_16x16x32_bf16 v[148:151], a[0:3], a[64:67], 0
    v_cmp_eq_u32 vcc, 0, v3
    v_lshrrev_b32 v7, 1, v2
    v_mfma_f32_16x16x32_bf16 v[152:155], a[32:35], a[64:67], 0
    v_lshlrev_b32 v7, 9, v7
    v_lshl_add_u32 v7, v1, 4, v7
    s_waitcnt lgkmcnt(6)
    v_mfma_f32_16x16x32_bf16 v[148:151], a[4:7], a[68:71], v[148:151]
    v_and_b32 v8, 1, v2
    v_lshl_add_u32 v7, v8, 3, v7
    v_mfma_f32_16x16x32_bf16 v[152:155], a[36:39], a[68:71], v[152:155]
    v_mov_b32 v8, s41
    v_cndmask_b32 v8, 0, v8, vcc
    s_waitcnt lgkmcnt(5)
    v_mfma_f32_16x16x32_bf16 v[148:151], a[8:11], a[72:75], v[148:151]
    v_add_f32 v140, v140, v8
    s_add_u32 s52, s27, 0x303e
    v_sub_u32 v5, s52, v7
    v_mfma_f32_16x16x32_bf16 v[152:155], a[40:43], a[72:75], v[152:155]
    v_cvt_pk_bf16_f32 v108, v143, v142
    v_cvt_pk_bf16_f32 v109, v141, v140
    s_waitcnt lgkmcnt(4)
    v_mfma_f32_16x16x32_bf16 v[148:151], a[12:15], a[76:79], v[148:151]
    ds_write_b64 v5, v[108:109] offset:258
    v_mfma_f32_16x16x32_bf16 v[152:155], a[44:47], a[76:79], v[152:155]
    ds_write_b16 v5, v108 offset:2368
    s_waitcnt lgkmcnt(5)
    v_mfma_f32_16x16x32_bf16 v[148:151], a[16:19], a[80:83], v[148:151]
    v_cvt_pk_bf16_f32 v114, v142, v141
    ds_write_b32 v5, v114 offset:2370
    v_mfma_f32_16x16x32_bf16 v[152:155], a[48:51], a[80:83], v[152:155]
    ds_write_b16_d16_hi v5, v109 offset:2374
    s_waitcnt lgkmcnt(6)
    v_mfma_f32_16x16x32_bf16 v[148:151], a[20:23], a[84:87], v[148:151]
    s_add_u32 s53, s27, 0x31f8
    s_add_u32 s58, s27, 0x33bc
    s_add_u32 s59, s27, 0x2d40
    v_lshl_add_u32 v6, v1, 2, s53
    v_mfma_f32_16x16x32_bf16 v[152:155], a[52:55], a[84:87], v[152:155]
    v_lshl_add_u32 v7, v1, 1, s58
    v_mov_b32 v9, s59
    s_waitcnt lgkmcnt(5)
    v_mfma_f32_16x16x32_bf16 v[148:151], a[24:27], a[88:91], v[148:151]
    v_cvt_pk_bf16_f32 v110, v144, v145
    v_cvt_pk_bf16_f32 v111, v146, v147
    v_mfma_f32_16x16x32_bf16 v[152:155], a[56:59], a[88:91], v[152:155]
    s_waitcnt lgkmcnt(4)
    v_mfma_f32_16x16x32_bf16 v[148:151], a[28:31], a[92:95], v[148:151]
    v_mfma_f32_16x16x32_bf16 v[152:155], a[60:63], a[92:95], v[152:155]
    s_mov_b64 exec, 0xffff
    ds_write2_b32 v6, v110, v111 offset0:0 offset1:32
    s_mov_b32 exec_lo, 0xffff0000
    ds_write_b16 v7, v110 offset:0
    ds_write_b16_d16_hi v7, v110 offset:64
    ds_write_b16 v7, v111 offset:128
    ds_write_b16_d16_hi v7, v111 offset:192
    s_mov_b64 exec, -1
    v_cvt_pk_bf16_f32 v116, v151, v150
    v_cvt_pk_bf16_f32 v117, v149, v148
    ds_write_b64 v5, v[116:117] offset:2
    ds_write_b16 v5, v116 offset:2112
    v_cvt_pk_bf16_f32 v122, v150, v149
    ds_write_b32 v5, v122 offset:2114
    ds_write_b16_d16_hi v5, v117 offset:2118
    v_cvt_pk_bf16_f32 v118, v152, v153
    v_cvt_pk_bf16_f32 v119, v154, v155
    v_cvt_pk_bf16_f32 v120, 0, v151
    v_cvt_pk_bf16_f32 v121, v151, v151
    s_brev_b64 exec, 1
    ds_write_b64 v9, v[120:121]
    ds_write_b32 v9, v121 offset:2112
    ds_write_b16 v9, v121 offset:2116
    s_mov_b64 exec, 0xffff
    ds_write2_b32 v6, v118, v119 offset0:16 offset1:48
    s_mov_b32 exec_lo, 0xffff0000
    ds_write_b16 v7, v118 offset:32
    ds_write_b16_d16_hi v7, v118 offset:96
    ds_write_b16 v7, v119 offset:160
    ds_write_b16_d16_hi v7, v119 offset:224
    s_mov_b64 exec, -1
    v_lshlrev_b32 v6, 3, v2
    v_sub_u32 v6, v6, v1
    v_cvt_f32_i32 v7, v6
    v_add_f32 v28, 0xc1000000, v7
    v_add_f32 v29, 0xc0e00000, v7
    v_add_f32 v30, 0xc0c00000, v7
    v_add_f32 v31, 0xc0a00000, v7
    v_add_f32 v32, -4.0, v7
    v_add_f32 v33, 0xc0400000, v7
    v_add_f32 v34, -2.0, v7
    v_add_f32 v35, -1.0, v7
    v_mov_b32 v8, 0x40400000
    v_sub_f32 v60, v8, |v28| clamp
    v_sub_f32 v61, v8, |v29| clamp
    v_sub_f32 v62, v8, |v30| clamp
    v_sub_f32 v63, v8, |v31| clamp
    v_sub_f32 v64, v8, |v32| clamp
    v_sub_f32 v65, v8, |v33| clamp
    v_sub_f32 v66, v8, |v34| clamp
    v_sub_f32 v67, v8, |v35| clamp
    v_sub_f32 v68, 4.0, |v28| clamp
    v_sub_f32 v69, 4.0, |v29| clamp
    v_sub_f32 v70, 4.0, |v30| clamp
    v_sub_f32 v71, 4.0, |v31| clamp
    v_sub_f32 v72, 4.0, |v32| clamp
    v_sub_f32 v73, 4.0, |v33| clamp
    v_sub_f32 v74, 4.0, |v34| clamp
    v_sub_f32 v75, 4.0, |v35| clamp
    v_cvt_pk_bf16_f32 v76, v60, v61
    v_cvt_pk_bf16_f32 v77, v62, v63
    v_cvt_pk_bf16_f32 v78, v64, v65
    v_cvt_pk_bf16_f32 v79, v66, v67
    v_cvt_pk_bf16_f32 v80, v68, v69
    v_cvt_pk_bf16_f32 v81, v70, v71
    v_cvt_pk_bf16_f32 v82, v72, v73
    v_cvt_pk_bf16_f32 v83, v74, v75
    v_mov_b32 v8, 0x40a00000
    v_add_f32 v36, 0xc1400000, v7
    v_add_f32 v37, 0xc1300000, v7
    v_add_f32 v38, 0xc1200000, v7
    v_add_f32 v39, 0xc1100000, v7
    v_add_f32 v40, 0xc1000000, v7
    v_add_f32 v41, 0xc0e00000, v7
    v_add_f32 v42, 0xc0c00000, v7
    v_add_f32 v43, 0xc0a00000, v7
    v_accvgpr_write_b32 a120, v80
    v_accvgpr_write_b32 a121, v81
    v_accvgpr_write_b32 a122, v82
    v_accvgpr_write_b32 a123, v83
    v_sub_f32 v60, v8, |v28| clamp
    v_sub_f32 v61, v8, |v29| clamp
    v_sub_f32 v62, v8, |v30| clamp
    v_sub_f32 v63, v8, |v31| clamp
    v_sub_f32 v64, v8, |v32| clamp
    v_sub_f32 v65, v8, |v33| clamp
    v_sub_f32 v66, v8, |v34| clamp
    v_sub_f32 v67, v8, |v35| clamp
    v_sub_f32 v68, 2.0, |v36| clamp
    v_sub_f32 v69, 2.0, |v37| clamp
    v_sub_f32 v70, 2.0, |v38| clamp
    v_sub_f32 v71, 2.0, |v39| clamp
    v_sub_f32 v72, 2.0, |v40| clamp
    v_sub_f32 v73, 2.0, |v41| clamp
    v_sub_f32 v74, 2.0, |v42| clamp
    v_sub_f32 v75, 2.0, |v43| clamp
    v_cvt_pk_bf16_f32 v80, v68, v69
    v_cvt_pk_bf16_f32 v81, v70, v71
    v_cvt_pk_bf16_f32 v82, v72, v73
    v_cvt_pk_bf16_f32 v83, v74, v75
    v_add_f32 v52, 0xc1480000, v7
    v_add_f32 v53, 0xc1380000, v7
    v_add_f32 v54, 0xc1280000, v7
    v_add_f32 v55, 0xc1180000, v7
    v_add_f32 v56, 0xc1080000, v7
    v_add_f32 v57, 0xc0f00000, v7
    v_add_f32 v58, 0xc0d00000, v7
    v_add_f32 v59, 0xc0b00000, v7
    v_mov_b32 v8, 0x3fc00000
    v_sub_f32 v68, v8, |v52| clamp
    v_sub_f32 v69, v8, |v53| clamp
    v_sub_f32 v70, v8, |v54| clamp
    v_sub_f32 v71, v8, |v55| clamp
    v_sub_f32 v72, v8, |v56| clamp
    v_sub_f32 v73, v8, |v57| clamp
    v_sub_f32 v74, v8, |v58| clamp
    v_sub_f32 v75, v8, |v59| clamp
    v_cvt_f32_u32 v5, v1
    v_cvt_f32_u32 v6, v2
    v_cvt_f32_u32 v4, s44
    v_mul_f32 v8, v5, v6
    v_mul_f32 v9, v4, v5
    v_mul_f32 v8, 0x3e800000, v8
    v_mul_f32 v9, 0x3c000000, v9
    v_add_f32 v44, -4.0, v7
    v_add_f32 v45, 0xc0400000, v7
    v_add_f32 v46, -2.0, v7
    v_add_f32 v47, -1.0, v7
    v_add_f32 v48, 0, v7
    v_add_f32 v49, 1.0, v7
    v_add_f32 v50, 2.0, v7
    v_add_f32 v51, 0x40400000, v7
    v_add_f32 v9, v9, v8
    v_mul_f32 v7, 0x3d800000, v5
    v_cos_f32 v117, v9
    v_sin_f32 v118, v9
    v_add_f32 v120, v9, v7
    v_add_f32 v124, v120, v7
    v_mul_f32 v9, 0x3d800000, v9
    v_add_f32 v128, v124, v7
    v_cos_f32 v228, v9
    v_sin_f32 v232, v9
    v_mul_f32 v7, 0x3d800000, v7
    v_add_f32 v9, v9, v7
    v_cos_f32 v229, v9
    v_sin_f32 v233, v9
    v_add_f32 v9, v9, v7
    v_cos_f32 v230, v9
    v_sin_f32 v234, v9
    v_add_f32 v9, v9, v7
    v_mul_f32 v7, 0x41000000, v5
    v_add_f32 v7, v7, v4
    v_mul_f32 v7, 0x3c000000, v7
    v_mul_f32 v8, v7, v6
    v_mul_f32 v8, 4.0, v8
    v_cos_f32 v133, v8
    v_sin_f32 v134, v8
    v_add_f32 v136, v8, v7
    v_add_f32 v140, v136, v7
    v_mul_f32 v8, 0x3d800000, v8
    v_add_f32 v144, v140, v7
    v_cos_f32 v220, v8
    v_sin_f32 v224, v8
    v_mul_f32 v7, 0x3d800000, v7
    v_add_f32 v8, v8, v7
    v_cos_f32 v221, v8
    v_sin_f32 v225, v8
    v_add_f32 v8, v8, v7
    v_cos_f32 v222, v8
    v_sin_f32 v226, v8
    s_lshl_b32 s58, s45, 3
    v_add_f32 v8, v8, v7
    s_lshl_b32 s59, s3, 1
    s_add_u32 s58, s58, s59
    v_cvt_f32_u32 v7, s58
    v_mul_f32 v7, 0x3a800000, v7
    v_sin_f32 v216, v7
    v_cos_f32 v217, v7
    v_add_f32 v7, 0x3a800000, v7
    v_sin_f32 v218, v7
    v_cos_f32 v219, v7
    v_lshlrev_b32 v7, 4, v1
    s_lshl_b32 s53, s3, 2
    v_lshl_add_u32 v7, v2, 10, v7
    s_add_u32 s52, s53, 0x4000
    s_sub_u32 s53, 0x600c, s53
    v_add_u32 v210, s52, v7
    v_add_u32 v209, s53, v7
    v_lshlrev_b32 v10, 6, v1
    v_lshl_add_u32 v10, v2, 12, v10
    v_lshrrev_b32 v7, 2, v1
    v_add_u32 v10, s21, v10
    v_xor_b32 v7, s20, v7
    v_lshl_add_u32 v214, v7, 4, v10
    v_bfe_u32 v7, v1, 1, 2
    v_xor_b32 v7, s20, v7
    v_lshl_add_u32 v212, v7, 4, v10
    v_bfe_u32 v7, v0, 3, 2
    v_cos_f32 v121, v120
    v_sin_f32 v122, v120
    v_cos_f32 v125, v124
    v_sin_f32 v126, v124
    v_cos_f32 v129, v128
    v_sin_f32 v130, v128
    v_cos_f32 v137, v136
    v_sin_f32 v138, v136
    v_cos_f32 v141, v140
    v_sin_f32 v142, v140
    v_cos_f32 v145, v144
    v_sin_f32 v146, v144
    v_accvgpr_write_b32 a112, v76
    v_accvgpr_write_b32 a113, v77
    v_accvgpr_write_b32 a114, v78
    v_accvgpr_write_b32 a115, v79
    v_xor_b32 v7, v7, v0
    v_cvt_pk_bf16_f32 v76, v60, v61
    v_cvt_pk_bf16_f32 v77, v62, v63
    v_cvt_pk_bf16_f32 v78, v64, v65
    v_cvt_pk_bf16_f32 v79, v66, v67
    v_lshlrev_b32 v240, 4, v7
    v_cos_f32 v223, v8
    v_sin_f32 v227, v8
    v_accvgpr_write_b32 a124, v76
    v_accvgpr_write_b32 a125, v77
    v_accvgpr_write_b32 a126, v78
    v_accvgpr_write_b32 a127, v79
    v_sub_f32 v60, 2.0, |v44| clamp
    v_sub_f32 v61, 2.0, |v45| clamp
    v_sub_f32 v62, 2.0, |v46| clamp
    v_sub_f32 v63, 2.0, |v47| clamp
    v_sub_f32 v64, 2.0, |v48| clamp
    v_sub_f32 v65, 2.0, |v49| clamp
    v_sub_f32 v66, 2.0, |v50| clamp
    v_sub_f32 v67, 2.0, |v51| clamp
    v_cvt_pk_bf16_f32 v236, v68, v69
    v_cvt_pk_bf16_f32 v237, v70, v71
    v_cvt_pk_bf16_f32 v238, v72, v73
    v_cvt_pk_bf16_f32 v239, v74, v75
    v_lshrrev_b32 v7, 2, v0
    v_xor_b32 v206, v3, v2
    v_cvt_pk_bf16_f32 v76, v60, v61
    v_cvt_pk_bf16_f32 v77, v62, v63
    v_cvt_pk_bf16_f32 v78, v64, v65
    v_cvt_pk_bf16_f32 v79, v66, v67
    v_lshrrev_b32 v236, 13, v236
    v_lshrrev_b32 v237, 13, v237
    v_lshrrev_b32 v238, 13, v238
    v_lshrrev_b32 v239, 13, v239
    v_cvt_pk_bf16_f32 v100, v117, v118
    v_cvt_pk_bf16_f32 v104, -v118, v117
    v_cvt_pk_bf16_f32 v101, v121, v122
    v_cvt_pk_bf16_f32 v105, -v122, v121
    v_cvt_pk_bf16_f32 v102, v125, v126
    v_cvt_pk_bf16_f32 v106, -v126, v125
    v_cvt_pk_bf16_f32 v103, v129, v130
    v_cvt_pk_bf16_f32 v107, -v130, v129
    v_cvt_pk_bf16_f32 v108, v133, v134
    v_cvt_pk_bf16_f32 v112, -v134, v133
    v_cvt_pk_bf16_f32 v109, v137, v138
    v_cvt_pk_bf16_f32 v113, -v138, v137
    v_cvt_pk_bf16_f32 v110, v141, v142
    v_cvt_pk_bf16_f32 v114, -v142, v141
    v_cvt_pk_bf16_f32 v111, v145, v146
    v_cvt_pk_bf16_f32 v115, -v146, v145
    v_mul_u32_u24 v7, 0x4100, v7
    v_and_b32 v8, 3, v0
    v_lshlrev_b32 v206, 4, v206
    v_lshlrev_b32 v205, 3, v1
    v_cos_f32 v231, v9
    v_sin_f32 v235, v9
    v_accvgpr_write_b32 a108, v80
    v_accvgpr_write_b32 a109, v81
    v_accvgpr_write_b32 a110, v82
    v_accvgpr_write_b32 a111, v83
    v_accvgpr_write_b32 a116, v76
    v_accvgpr_write_b32 a117, v77
    v_accvgpr_write_b32 a118, v78
    v_accvgpr_write_b32 a119, v79
    v_and_b32 v236, 0x10001, v236
    v_and_b32 v237, 0x10001, v237
    v_and_b32 v238, 0x10001, v238
    v_and_b32 v239, 0x10001, v239
    v_accvgpr_write_b32 a144, v100
    v_accvgpr_write_b32 a145, v101
    v_accvgpr_write_b32 a146, v102
    v_accvgpr_write_b32 a147, v103
    v_accvgpr_write_b32 a148, v104
    v_accvgpr_write_b32 a149, v105
    v_accvgpr_write_b32 a150, v106
    v_accvgpr_write_b32 a151, v107
    v_accvgpr_write_b32 a136, v108
    v_accvgpr_write_b32 a137, v109
    v_accvgpr_write_b32 a138, v110
    v_accvgpr_write_b32 a139, v111
    v_accvgpr_write_b32 a140, v112
    v_accvgpr_write_b32 a141, v113
    v_accvgpr_write_b32 a142, v114
    v_accvgpr_write_b32 a143, v115
    v_fma_f32 v216, v216, -0.5, 0.5
    v_mul_f32 v217, 0.5, v217
    v_fma_f32 v218, v218, -0.5, 0.5
    v_mul_f32 v219, 0.5, v219
    v_xor_b32 v215, 32, v214
    v_xor_b32 v213, 32, v212
    v_lshl_add_u32 v211, v8, 4, v7
    v_add_u32 v206, s35, v206
    v_lshl_add_u32 v205, v2, 9, v205
    s_mov_b32 s57, 0x20000
    s_waitcnt vmcnt(0)
    s_branch tc_2
tl_1:
    s_add_u32 m0, s27, 0x3d00
    s_nop 0
    buffer_load_dwordx4 v208, s[4:7], s26 offen sc1 lds
    buffer_load_dwordx4 v208, s[4:7], s26 offen offset:1024 sc1 lds
    buffer_load_dwordx4 v208, s[4:7], s26 offen offset:2048 sc1 lds
    buffer_load_dwordx4 v208, s[4:7], s26 offen offset:3072 sc1 lds
    s_waitcnt vmcnt(0)
tc_2:
    ds_read_b128 v[84:87], v247 offset:15616
    ds_read_b128 v[88:91], v247 offset:16640
    ds_read_b128 v[92:95], v247 offset:17664
    ds_read_b128 v[96:99], v247 offset:18688
    s_waitcnt lgkmcnt(3)
    v_xor_b32 v4, v84, v199
    v_xor_b32 v5, v85, v200
    v_xor_b32 v6, v86, v201
    v_xor_b32 v7, v87, v202
    s_waitcnt lgkmcnt(2)
    v_bitop3_b32 v4, v4, v88, v199 bitop3:0xf6
    v_bitop3_b32 v5, v5, v89, v200 bitop3:0xf6
    v_bitop3_b32 v6, v6, v90, v201 bitop3:0xf6
    v_bitop3_b32 v7, v7, v91, v202 bitop3:0xf6
    s_waitcnt lgkmcnt(1)
    v_bitop3_b32 v4, v4, v92, v199 bitop3:0xf6
    v_bitop3_b32 v5, v5, v93, v200 bitop3:0xf6
    v_bitop3_b32 v6, v6, v94, v201 bitop3:0xf6
    v_bitop3_b32 v7, v7, v95, v202 bitop3:0xf6
    s_waitcnt lgkmcnt(0)
    v_bitop3_b32 v4, v4, v96, v199 bitop3:0xf6
    v_bitop3_b32 v5, v5, v97, v200 bitop3:0xf6
    v_bitop3_b32 v6, v6, v98, v201 bitop3:0xf6
    v_bitop3_b32 v7, v7, v99, v202 bitop3:0xf6
    v_or3_b32 v4, v4, v5, v6
    v_or_b32 v4, v4, v7
    v_and_b32 v4, s55, v4
    s_nop 1
    v_or_b32_dpp v4, v4, v4 quad_perm:[1,0,3,2] row_mask:0xf bank_mask:0xf
    s_nop 1
    v_or_b32_dpp v4, v4, v4 quad_perm:[2,3,0,1] row_mask:0xf bank_mask:0xf
    v_cmp_ne_u32 vcc, 0, v4
    s_nop 0
    s_and_b64 exec, exec, vcc
    s_cbranch_scc0 td_3
    s_sub_u32 s57, s57, 1
    s_cbranch_scc0 tl_1
td_3:
    s_mov_b64 exec, -1
    v_and_b32 v11, 0x7ff, v207
    v_mul_u32_u24 v11, 0x402, v11
    s_add_u32 m0, s35, 0x4000
    v_add_u32 v207, s50, v207
    buffer_load_dwordx4 v11, s[12:15], s49 offen lds
    ds_read_b128 a[40:43], v246 offset:480
    v_and_b32 v11, 0x7ff, v207
    v_mul_u32_u24 v11, 0x402, v11
    s_add_u32 m0, s35, 0x4400
    s_nop 0
    buffer_load_dwordx4 v11, s[12:15], s49 offen lds
    ds_read_b128 a[44:47], v246 offset:464
    v_add_u32 v207, s50, v207
    v_and_b32 v11, 0x7ff, v207
    v_mul_u32_u24 v11, 0x402, v11
    ds_read_b128 a[48:51], v246 offset:992
    s_add_u32 m0, s35, 0x4800
    v_add_u32 v207, s50, v207
    v_accvgpr_write_b32 a168, v12
    v_accvgpr_write_b32 a169, v13
    ds_read_b128 a[52:55], v246 offset:976
    v_accvgpr_write_b32 a170, v14
    v_accvgpr_write_b32 a171, v15
    v_accvgpr_write_b32 a172, v16
    ds_read2_b32 a[16:17], v243 offset0:70 offset1:68
    v_accvgpr_write_b32 a173, v17
    v_accvgpr_write_b32 a174, v18
    v_accvgpr_write_b32 a175, v19
    ds_read2_b32 a[18:19], v243 offset0:66 offset1:64
    v_accvgpr_write_b32 a176, v20
    v_accvgpr_write_b32 a177, v21
    s_waitcnt lgkmcnt(5)
    v_mfma_f32_16x16x32_bf16 v[60:63], a[40:43], a[108:111], 0
    ds_read2_b32 a[0:1], v243 offset0:6 offset1:4
    v_accvgpr_write_b32 a178, v22
    v_mfma_f32_16x16x32_bf16 v[64:67], a[40:43], a[112:115], 0
    ds_read2_b32 a[2:3], v243 offset0:2 offset1:0
    v_accvgpr_write_b32 a179, v23
    v_mfma_f32_16x16x32_bf16 v[68:71], a[40:43], a[116:119], 0
    ds_read2_b32 a[8:9], v243 offset0:38 offset1:36
    v_accvgpr_write_b32 a180, v24
    s_waitcnt lgkmcnt(7)
    v_mfma_f32_16x16x32_bf16 v[72:75], a[44:47], a[112:115], 0
    ds_read2_b32 a[10:11], v243 offset0:34 offset1:32
    v_cvt_pk_bf16_f32 v84, v60, v64
    v_mfma_f32_16x16x32_bf16 v[76:79], a[40:43], a[120:123], 0
    ds_read2_b32 a[20:21], v243 offset0:71 offset1:69
    v_cvt_pk_bf16_f32 v85, v61, v65
    v_mfma_f32_16x16x32_bf16 v[80:83], a[44:47], a[124:127], 0
    ds_read2_b32 a[22:23], v243 offset0:67 offset1:65
    v_cvt_pk_bf16_f32 v86, v62, v66
    v_cvt_pk_bf16_f32 v87, v63, v67
    v_cvt_pk_bf16_f32 v88, v68, v72
    ds_read2_b32 a[4:5], v243 offset0:7 offset1:5
    v_cvt_pk_bf16_f32 v89, v69, v73
    v_cvt_pk_bf16_f32 v90, v70, v74
    v_cvt_pk_bf16_f32 v91, v71, v75
    ds_read2_b32 a[6:7], v243 offset0:3 offset1:1
    v_cvt_pk_bf16_f32 v92, v76, v80
    v_cvt_pk_bf16_f32 v93, v77, v81
    v_cvt_pk_bf16_f32 v94, v78, v82
    ds_read2_b32 a[12:13], v243 offset0:39 offset1:37
    v_cvt_pk_bf16_f32 v95, v79, v83
    s_waitcnt lgkmcnt(12)
    v_mfma_f32_16x16x32_bf16 v[60:63], a[48:51], a[108:111], 0
    ds_read2_b32 a[14:15], v243 offset0:35 offset1:33
    v_accvgpr_write_b32 a181, v25
    v_mfma_f32_16x16x32_bf16 v[64:67], a[48:51], a[112:115], 0
    ds_read2_b32 a[24:25], v242 offset0:3 offset1:2
    v_accvgpr_write_b32 a182, v26
    v_mfma_f32_16x16x32_bf16 v[68:71], a[48:51], a[116:119], 0
    ds_read2_b32 a[26:27], v242 offset0:1 offset1:0
    v_accvgpr_write_b32 a183, v27
    v_mfma_f32_16x16x32_bf16 v[76:79], a[48:51], a[120:123], 0
    ds_read2_b32 a[28:29], v242 offset0:19 offset1:18
    s_waitcnt lgkmcnt(15)
    v_mfma_f32_16x16x32_bf16 v[72:75], a[52:55], a[112:115], 0
    ds_read2_b32 a[30:31], v242 offset0:17 offset1:16
    v_mfma_f32_16x16x32_bf16 v[80:83], a[52:55], a[124:127], 0
    ds_read2_b32 a[32:33], v242 offset0:35 offset1:34
    s_waitcnt lgkmcnt(15)
    v_mfma_f32_16x16x32_bf16 v[44:47], v[84:87], a[16:19], 0
    ds_read2_b32 a[34:35], v242 offset0:33 offset1:32
    s_waitcnt lgkmcnt(14)
    v_mfma_f32_16x16x32_bf16 v[36:39], v[84:87], a[0:3], 0
    ds_read2_b32 a[36:37], v242 offset0:51 offset1:50
    s_waitcnt lgkmcnt(13)
    v_mfma_f32_16x16x32_bf16 v[40:43], v[84:87], a[8:11], 0
    ds_read2_b32 a[38:39], v242 offset0:49 offset1:48
    v_cvt_pk_bf16_f32 v84, v60, v64
    s_waitcnt lgkmcnt(12)
    v_mfma_f32_16x16x32_bf16 v[44:47], v[88:91], a[20:23], v[44:47]
    ds_read_b128 a[40:43], v246 offset:1504
    v_cvt_pk_bf16_f32 v85, v61, v65
    s_waitcnt lgkmcnt(11)
    v_mfma_f32_16x16x32_bf16 v[36:39], v[88:91], a[4:7], v[36:39]
    ds_read_b128 a[44:47], v246 offset:1488
    v_cvt_pk_bf16_f32 v86, v62, v66
    s_waitcnt lgkmcnt(10)
    v_mfma_f32_16x16x32_bf16 v[40:43], v[88:91], a[12:15], v[40:43]
    ds_read_b128 a[48:51], v246 offset:2016
    v_cvt_pk_bf16_f32 v87, v63, v67
    s_waitcnt lgkmcnt(9)
    v_mfma_f32_16x16x32_bf16 v[44:47], v[92:95], a[24:27], v[44:47]
    ds_read_b128 a[52:55], v246 offset:2000
    v_cvt_pk_bf16_f32 v88, v68, v72
    s_waitcnt lgkmcnt(8)
    v_mfma_f32_16x16x32_bf16 v[48:51], v[92:95], a[28:31], 0
    v_cvt_pk_bf16_f32 v89, v69, v73
    v_cvt_pk_bf16_f32 v90, v70, v74
    s_waitcnt lgkmcnt(6)
    v_mfma_f32_16x16x32_bf16 v[52:55], v[92:95], a[32:35], 0
    v_cvt_pk_bf16_f32 v91, v71, v75
    ds_read_u16 v241, v241
    v_mfma_f32_16x16x32_bf16 v[48:51], v[84:87], a[16:19], v[48:51]
    ds_read_b128 a[56:59], v246 offset:480
    buffer_load_dwordx4 v11, s[12:15], s49 offen lds
    s_waitcnt lgkmcnt(6)
    v_mfma_f32_16x16x32_bf16 v[56:59], v[92:95], a[36:39], 0
    v_cvt_pk_bf16_f32 v92, v76, v80
    v_cvt_pk_bf16_f32 v93, v77, v81
    v_cvt_pk_bf16_f32 v94, v78, v82
    v_cvt_pk_bf16_f32 v95, v79, v83
    s_waitcnt lgkmcnt(5)
    v_mfma_f32_16x16x32_bf16 v[60:63], a[40:43], a[108:111], 0
    ds_read2_b32 a[104:105], v244 offset0:0 offset1:1
    v_and_b32 v11, 0x7ff, v207
    v_mfma_f32_16x16x32_bf16 v[64:67], a[40:43], a[112:115], 0
    ds_read2_b32 a[106:107], v244 offset0:2 offset1:3
    v_mul_u32_u24 v11, 0x402, v11
    v_mfma_f32_16x16x32_bf16 v[68:71], a[40:43], a[116:119], 0
    ds_read_b128 a[60:63], v246 offset:992
    s_add_u32 m0, s35, 0x4c00
    s_waitcnt lgkmcnt(7)
    v_mfma_f32_16x16x32_bf16 v[72:75], a[44:47], a[112:115], 0
    ds_read_b128 a[64:67], v246 offset:1504
    s_waitcnt lgkmcnt(5)
    v_mul_u32_u24 v236, v236, v241
    v_mfma_f32_16x16x32_bf16 v[76:79], a[40:43], a[120:123], 0
    ds_read_b128 a[40:43], v246 offset:2528
    v_mul_u32_u24 v237, v237, v241
    v_mfma_f32_16x16x32_bf16 v[80:83], a[44:47], a[124:127], 0
    ds_read_b128 a[44:47], v246 offset:2512
    v_mul_u32_u24 v238, v238, v241
    v_mfma_f32_16x16x32_bf16 v[40:43], v[84:87], a[0:3], v[40:43]
    ds_read2_b32 a[92:93], v245 offset0:0 offset1:1
    v_mul_u32_u24 v239, v239, v241
    v_mfma_f32_16x16x32_bf16 v[44:47], v[84:87], a[8:11], v[44:47]
    v_cvt_pk_bf16_f32 v84, v60, v64
    v_cvt_pk_bf16_f32 v85, v61, v65
    v_mfma_f32_16x16x32_bf16 v[48:51], v[88:91], a[20:23], v[48:51]
    v_cvt_pk_bf16_f32 v86, v62, v66
    v_cvt_pk_bf16_f32 v87, v63, v67
    v_mfma_f32_16x16x32_bf16 v[40:43], v[88:91], a[4:7], v[40:43]
    ds_read2_b32 a[94:95], v245 offset0:2 offset1:3
    v_mfma_f32_16x16x32_bf16 v[44:47], v[88:91], a[12:15], v[44:47]
    v_cvt_pk_bf16_f32 v88, v68, v72
    v_cvt_pk_bf16_f32 v89, v69, v73
    v_mfma_f32_16x16x32_bf16 v[48:51], v[92:95], a[24:27], v[48:51]
    v_cvt_pk_bf16_f32 v90, v70, v74
    v_cvt_pk_bf16_f32 v91, v71, v75
    v_mfma_f32_16x16x32_bf16 v[52:55], v[92:95], a[28:31], v[52:55]
    ds_read_b128 a[68:71], v246 offset:2016
    v_mfma_f32_16x16x32_bf16 v[56:59], v[92:95], a[32:35], v[56:59]
    v_cvt_pk_bf16_f32 v92, v76, v80
    v_cvt_pk_bf16_f32 v93, v77, v81
    v_cvt_pk_bf16_f32 v94, v78, v82
    v_cvt_pk_bf16_f32 v95, v79, v83
    v_mfma_f32_16x16x32_bf16 v[60:63], a[48:51], a[108:111], 0
    ds_read2_b32 a[88:89], v245 offset0:128 offset1:129
    v_mfma_f32_16x16x32_bf16 v[64:67], a[48:51], a[112:115], 0
    ds_read2_b32 a[90:91], v245 offset0:130 offset1:131
    v_mfma_f32_16x16x32_bf16 v[68:71], a[48:51], a[116:119], 0
    ds_read_b128 a[72:75], v246 offset:2528
    v_mfma_f32_16x16x32_bf16 v[76:79], a[48:51], a[120:123], 0
    ds_read_b128 a[48:51], v246 offset:3040
    v_mfma_f32_16x16x32_bf16 v[72:75], a[52:55], a[112:115], 0
    ds_read_b128 a[76:79], v246 offset:3040
    v_mfma_f32_16x16x32_bf16 v[80:83], a[52:55], a[124:127], 0
    ds_read_b128 a[52:55], v246 offset:3024
    v_mfma_f32_16x16x32_bf16 v[44:47], v[84:87], a[0:3], v[44:47]
    ds_read_b128 a[80:83], v246 offset:3552
    v_mfma_f32_16x16x32_bf16 v[48:51], v[84:87], a[8:11], v[48:51]
    ds_read_b128 a[84:87], v246 offset:4064
    v_mfma_f32_16x16x32_bf16 v[52:55], v[84:87], a[16:19], v[52:55]
    v_cvt_pk_bf16_f32 v84, v60, v64
    v_cvt_pk_bf16_f32 v85, v61, v65
    v_mfma_f32_16x16x32_bf16 v[56:59], v[92:95], a[28:31], v[56:59]
    v_cvt_pk_bf16_f32 v86, v62, v66
    v_cvt_pk_bf16_f32 v87, v63, v67
    s_waitcnt lgkmcnt(12)
    v_mfma_f32_16x16x32_bf16 v[60:63], a[40:43], a[108:111], 0
    ds_read2_b32 a[100:101], v244 offset0:112 offset1:113
    v_mfma_f32_16x16x32_bf16 v[64:67], a[40:43], a[112:115], 0
    ds_read2_b32 a[102:103], v244 offset0:114 offset1:115
    v_mfma_f32_16x16x32_bf16 v[44:47], v[88:91], a[4:7], v[44:47]
    ds_read2_b32 a[96:97], v245 offset0:112 offset1:113
    v_mfma_f32_16x16x32_bf16 v[48:51], v[88:91], a[12:15], v[48:51]
    ds_read2_b32 a[98:99], v245 offset0:114 offset1:115
    buffer_load_dwordx4 v11, s[12:15], s49 offen lds
    v_mfma_f32_16x16x32_bf16 v[52:55], v[88:91], a[20:23], v[52:55]
    v_cvt_pk_bf16_f32 v88, v68, v72
    v_cvt_pk_bf16_f32 v89, v69, v73
    v_mfma_f32_16x16x32_bf16 v[56:59], v[84:87], a[16:19], v[56:59]
    v_cvt_pk_bf16_f32 v90, v70, v74
    v_cvt_pk_bf16_f32 v91, v71, v75
    v_mfma_f32_16x16x32_bf16 v[68:71], a[40:43], a[116:119], 0
    s_waitcnt lgkmcnt(15)
    v_mfma_f32_16x16x32_bf16 v[72:75], a[44:47], a[112:115], 0
    v_mfma_f32_16x16x32_bf16 v[52:55], v[92:95], a[24:27], v[52:55]
    v_cvt_pk_bf16_f32 v92, v76, v80
    v_cvt_pk_bf16_f32 v93, v77, v81
    v_mfma_f32_16x16x32_bf16 v[56:59], v[88:91], a[20:23], v[56:59]
    v_cvt_pk_bf16_f32 v94, v78, v82
    v_cvt_pk_bf16_f32 v95, v79, v83
    s_waitcnt lgkmcnt(8)
    v_mfma_f32_16x16x32_bf16 v[76:79], a[48:51], a[108:111], 0
    v_mfma_f32_16x16x32_bf16 v[80:83], a[48:51], a[112:115], 0
    v_mfma_f32_16x16x32_bf16 v[48:51], v[84:87], a[0:3], v[48:51]
    v_mfma_f32_16x16x32_bf16 v[52:55], v[84:87], a[8:11], v[52:55]
    v_cvt_pk_bf16_f32 v84, v60, v64
    v_cvt_pk_bf16_f32 v85, v61, v65
    v_mfma_f32_16x16x32_bf16 v[56:59], v[92:95], a[24:27], v[56:59]
    v_cvt_pk_bf16_f32 v86, v62, v66
    v_cvt_pk_bf16_f32 v87, v63, v67
    v_mfma_f32_16x16x32_bf16 v[60:63], a[48:51], a[116:119], 0
    v_cvt_pk_bf16_f32 v92, v76, v80
    v_cvt_pk_bf16_f32 v93, v77, v81
    s_waitcnt lgkmcnt(6)
    v_mfma_f32_16x16x32_bf16 v[64:67], a[52:55], a[112:115], 0
    v_cvt_pk_bf16_f32 v94, v78, v82
    v_cvt_pk_bf16_f32 v95, v79, v83
    v_mfma_f32_16x16x32_bf16 v[48:51], v[88:91], a[4:7], v[48:51]
    v_mfma_f32_16x16x32_bf16 v[52:55], v[88:91], a[12:15], v[52:55]
    v_cvt_pk_bf16_f32 v88, v68, v72
    v_cvt_pk_bf16_f32 v89, v69, v73
    v_mfma_f32_16x16x32_bf16 v[56:59], v[84:87], a[8:11], v[56:59]
    v_cvt_pk_bf16_f32 v90, v70, v74
    v_cvt_pk_bf16_f32 v91, v71, v75
    v_mfma_f32_16x16x32_bf16 v[52:55], v[84:87], a[0:3], v[52:55]
    v_cvt_pk_bf16_f32 v84, v60, v64
    v_cvt_pk_bf16_f32 v85, v61, v65
    v_mfma_f32_16x16x32_bf16 v[56:59], v[88:91], a[12:15], v[56:59]
    v_cvt_pk_bf16_f32 v86, v62, v66
    v_cvt_pk_bf16_f32 v87, v63, v67
    v_mfma_f32_16x16x32_bf16 v[44:47], v[236:239], a[56:59], v[44:47]
    v_mfma_f32_16x16x32_bf16 v[52:55], v[88:91], a[4:7], v[52:55]
    v_mfma_f32_16x16x32_bf16 v[56:59], v[92:95], a[0:3], v[56:59]
    v_mfma_f32_16x16x32_bf16 v[36:39], a[104:107], a[56:59], v[36:39]
    v_mfma_f32_16x16x32_bf16 v[40:43], a[104:107], a[60:63], v[40:43]
    v_mfma_f32_16x16x32_bf16 v[48:51], v[236:239], a[60:63], v[48:51]
    v_mfma_f32_16x16x32_bf16 v[44:47], a[104:107], a[64:67], v[44:47]
    v_mfma_f32_16x16x32_bf16 v[56:59], v[84:87], a[4:7], v[56:59]
    v_mfma_f32_16x16x32_bf16 v[32:35], a[92:95], a[56:59], 0
    v_mfma_f32_16x16x32_bf16 v[36:39], a[92:95], a[60:63], v[36:39]
    v_mfma_f32_16x16x32_bf16 v[40:43], a[92:95], a[64:67], v[40:43]
    v_mfma_f32_16x16x32_bf16 v[52:55], v[236:239], a[64:67], v[52:55]
    v_mfma_f32_16x16x32_bf16 v[44:47], a[92:95], a[68:71], v[44:47]
    v_mfma_f32_16x16x32_bf16 v[48:51], a[104:107], a[68:71], v[48:51]
    v_mfma_f32_16x16x32_bf16 v[28:31], a[88:91], a[56:59], 0
    ds_read_b128 a[56:59], v246 offset:416
    v_mfma_f32_16x16x32_bf16 v[32:35], a[88:91], a[60:63], v[32:35]
    ds_read_b128 a[60:63], v246 offset:928
    v_mfma_f32_16x16x32_bf16 v[36:39], a[88:91], a[64:67], v[36:39]
    ds_read_b128 a[64:67], v246 offset:1440
    v_mfma_f32_16x16x32_bf16 v[40:43], a[88:91], a[68:71], v[40:43]
    v_mfma_f32_16x16x32_bf16 v[56:59], v[236:239], a[68:71], v[56:59]
    ds_read_b128 a[68:71], v246 offset:1952
    v_mfma_f32_16x16x32_bf16 v[44:47], a[88:91], a[72:75], v[44:47]
    v_mfma_f32_16x16x32_bf16 v[48:51], a[92:95], a[72:75], v[48:51]
    v_mfma_f32_16x16x32_bf16 v[52:55], a[104:107], a[72:75], v[52:55]
    ds_read_b128 a[72:75], v246 offset:2464
    v_mfma_f32_16x16x32_bf16 v[48:51], a[88:91], a[76:79], v[48:51]
    v_mfma_f32_16x16x32_bf16 v[52:55], a[92:95], a[76:79], v[52:55]
    v_mfma_f32_16x16x32_bf16 v[56:59], a[104:107], a[76:79], v[56:59]
    ds_read_b128 a[76:79], v246 offset:2976
    s_waitcnt lgkmcnt(11)
    v_mfma_f32_16x16x32_bf16 v[52:55], a[88:91], a[80:83], v[52:55]
    v_mfma_f32_16x16x32_bf16 v[56:59], a[92:95], a[80:83], v[56:59]
    ds_read_b128 a[80:83], v246 offset:3488
    s_waitcnt lgkmcnt(11)
    v_mfma_f32_16x16x32_bf16 v[56:59], a[88:91], a[84:87], v[56:59]
    ds_read_b128 a[84:87], v246 offset:4000
    s_waitcnt lgkmcnt(7)
    v_mfma_f32_16x16x32_bf16 v[32:35], a[100:103], a[56:59], v[32:35]
    ds_read2_b32 a[92:93], v244 offset0:96 offset1:97
    s_waitcnt lgkmcnt(7)
    v_mfma_f32_16x16x32_bf16 v[36:39], a[100:103], a[60:63], v[36:39]
    ds_read2_b32 a[94:95], v244 offset0:98 offset1:99
    s_waitcnt lgkmcnt(7)
    v_mfma_f32_16x16x32_bf16 v[40:43], a[100:103], a[64:67], v[40:43]
    ds_read2_b32 a[88:89], v245 offset0:96 offset1:97
    s_waitcnt lgkmcnt(7)
    v_mfma_f32_16x16x32_bf16 v[44:47], a[100:103], a[68:71], v[44:47]
    ds_read2_b32 a[90:91], v245 offset0:98 offset1:99
    s_waitcnt lgkmcnt(7)
    v_mfma_f32_16x16x32_bf16 v[48:51], a[100:103], a[72:75], v[48:51]
    v_mfma_f32_16x16x32_bf16 v[28:31], a[96:99], a[56:59], v[28:31]
    ds_read_b128 a[56:59], v246 offset:352
    v_mfma_f32_16x16x32_bf16 v[32:35], a[96:99], a[60:63], v[32:35]
    ds_read_b128 a[60:63], v246 offset:864
    v_mfma_f32_16x16x32_bf16 v[36:39], a[96:99], a[64:67], v[36:39]
    ds_read_b128 a[64:67], v246 offset:1376
    v_mfma_f32_16x16x32_bf16 v[40:43], a[96:99], a[68:71], v[40:43]
    ds_read_b128 a[68:71], v246 offset:1888
    v_mfma_f32_16x16x32_bf16 v[44:47], a[96:99], a[72:75], v[44:47]
    ds_read_b128 a[72:75], v246 offset:2400
    s_waitcnt lgkmcnt(11)
    v_mfma_f32_16x16x32_bf16 v[48:51], a[96:99], a[76:79], v[48:51]
    v_mfma_f32_16x16x32_bf16 v[52:55], a[100:103], a[76:79], v[52:55]
    ds_read_b128 a[76:79], v246 offset:2912
    s_waitcnt lgkmcnt(11)
    v_mfma_f32_16x16x32_bf16 v[52:55], a[96:99], a[80:83], v[52:55]
    v_mfma_f32_16x16x32_bf16 v[56:59], a[100:103], a[80:83], v[56:59]
    ds_read_b128 a[80:83], v246 offset:3424
    s_waitcnt lgkmcnt(11)
    v_mfma_f32_16x16x32_bf16 v[56:59], a[96:99], a[84:87], v[56:59]
    ds_read_b128 a[84:87], v246 offset:3936
    s_waitcnt lgkmcnt(7)
    v_mfma_f32_16x16x32_bf16 v[32:35], a[92:95], a[56:59], v[32:35]
    ds_read2_b32 a[100:101], v244 offset0:80 offset1:81
    s_waitcnt lgkmcnt(7)
    v_mfma_f32_16x16x32_bf16 v[36:39], a[92:95], a[60:63], v[36:39]
    ds_read2_b32 a[102:103], v244 offset0:82 offset1:83
    s_waitcnt lgkmcnt(7)
    v_mfma_f32_16x16x32_bf16 v[40:43], a[92:95], a[64:67], v[40:43]
    ds_read2_b32 a[96:97], v245 offset0:80 offset1:81
    s_waitcnt lgkmcnt(7)
    v_mfma_f32_16x16x32_bf16 v[44:47], a[92:95], a[68:71], v[44:47]
    ds_read2_b32 a[98:99], v245 offset0:82 offset1:83
    s_waitcnt lgkmcnt(7)
    v_mfma_f32_16x16x32_bf16 v[48:51], a[92:95], a[72:75], v[48:51]
    s_waitcnt lgkmcnt(6)
    v_mfma_f32_16x16x32_bf16 v[52:55], a[92:95], a[76:79], v[52:55]
    v_mfma_f32_16x16x32_bf16 v[28:31], a[88:91], a[56:59], v[28:31]
    ds_read_b128 a[56:59], v246 offset:288
    v_mfma_f32_16x16x32_bf16 v[32:35], a[88:91], a[60:63], v[32:35]
    ds_read_b128 a[60:63], v246 offset:800
    v_mfma_f32_16x16x32_bf16 v[36:39], a[88:91], a[64:67], v[36:39]
    ds_read_b128 a[64:67], v246 offset:1312
    v_mfma_f32_16x16x32_bf16 v[40:43], a[88:91], a[68:71], v[40:43]
    ds_read_b128 a[68:71], v246 offset:1824
    v_mfma_f32_16x16x32_bf16 v[44:47], a[88:91], a[72:75], v[44:47]
    ds_read_b128 a[72:75], v246 offset:2336
    v_mfma_f32_16x16x32_bf16 v[48:51], a[88:91], a[76:79], v[48:51]
    ds_read_b128 a[76:79], v246 offset:2848
    s_waitcnt lgkmcnt(11)
    v_mfma_f32_16x16x32_bf16 v[52:55], a[88:91], a[80:83], v[52:55]
    v_mfma_f32_16x16x32_bf16 v[56:59], a[92:95], a[80:83], v[56:59]
    ds_read_b128 a[80:83], v246 offset:3360
    s_waitcnt lgkmcnt(11)
    v_mfma_f32_16x16x32_bf16 v[56:59], a[88:91], a[84:87], v[56:59]
    ds_read_b128 a[84:87], v246 offset:3872
    s_waitcnt lgkmcnt(7)
    v_mfma_f32_16x16x32_bf16 v[32:35], a[100:103], a[56:59], v[32:35]
    ds_read2_b32 a[88:89], v245 offset0:64 offset1:65
    s_waitcnt lgkmcnt(7)
    v_mfma_f32_16x16x32_bf16 v[36:39], a[100:103], a[60:63], v[36:39]
    ds_read2_b32 a[90:91], v245 offset0:66 offset1:67
    s_waitcnt lgkmcnt(7)
    v_mfma_f32_16x16x32_bf16 v[40:43], a[100:103], a[64:67], v[40:43]
    ds_read2_b32 a[92:93], v244 offset0:64 offset1:65
    s_waitcnt lgkmcnt(7)
    v_mfma_f32_16x16x32_bf16 v[44:47], a[100:103], a[68:71], v[44:47]
    ds_read2_b32 a[94:95], v244 offset0:66 offset1:67
    s_waitcnt lgkmcnt(7)
    v_mfma_f32_16x16x32_bf16 v[48:51], a[100:103], a[72:75], v[48:51]
    s_waitcnt lgkmcnt(6)
    v_mfma_f32_16x16x32_bf16 v[52:55], a[100:103], a[76:79], v[52:55]
    s_waitcnt lgkmcnt(5)
    v_mfma_f32_16x16x32_bf16 v[56:59], a[100:103], a[80:83], v[56:59]
    v_mfma_f32_16x16x32_bf16 v[28:31], a[96:99], a[56:59], v[28:31]
    ds_read_b128 a[56:59], v246 offset:224
    v_mfma_f32_16x16x32_bf16 v[32:35], a[96:99], a[60:63], v[32:35]
    ds_read_b128 a[60:63], v246 offset:736
    v_mfma_f32_16x16x32_bf16 v[36:39], a[96:99], a[64:67], v[36:39]
    ds_read_b128 a[64:67], v246 offset:1248
    v_mfma_f32_16x16x32_bf16 v[40:43], a[96:99], a[68:71], v[40:43]
    ds_read_b128 a[68:71], v246 offset:1760
    v_mfma_f32_16x16x32_bf16 v[44:47], a[96:99], a[72:75], v[44:47]
    ds_read_b128 a[72:75], v246 offset:2272
    v_mfma_f32_16x16x32_bf16 v[48:51], a[96:99], a[76:79], v[48:51]
    ds_read_b128 a[76:79], v246 offset:2784
    v_mfma_f32_16x16x32_bf16 v[52:55], a[96:99], a[80:83], v[52:55]
    ds_read_b128 a[80:83], v246 offset:3296
    s_waitcnt lgkmcnt(11)
    v_mfma_f32_16x16x32_bf16 v[56:59], a[96:99], a[84:87], v[56:59]
    ds_read_b128 a[84:87], v246 offset:3808
    s_mul_i32 s22, s46, 0x4100
    s_add_u32 s22, s22, s35
    s_lshl_b32 s23, s44, 12
    s_add_u32 s23, s23, 0x1200000
    v_lshlrev_b32 v11, 1, v205
    s_waitcnt vmcnt(0)
    s_barrier
    buffer_load_dwordx4 v[132:135], v208, s[4:7], s22 offen sc1
    buffer_load_dwordx4 v[136:139], v208, s[4:7], s22 offen offset:1024 sc1
    buffer_load_dwordx4 v[140:143], v208, s[4:7], s22 offen offset:2048 sc1
    buffer_load_dwordx4 v[144:147], v208, s[4:7], s22 offen offset:3072 sc1
    s_cmp_eq_u32 s51, 0
    s_cbranch_scc0 k_noc1
    buffer_load_dwordx4 v[116:119], v11, s[4:7], s23 offen sc1
    buffer_load_dwordx4 v[120:123], v11, s[4:7], s23 offen offset:256 sc1
    buffer_load_dwordx4 v[124:127], v11, s[4:7], s23 offen offset:512 sc1
    buffer_load_dwordx4 v[128:131], v11, s[4:7], s23 offen offset:768 sc1
k_noc1:
    s_waitcnt lgkmcnt(7)
    v_mfma_f32_16x16x32_bf16 v[32:35], a[92:95], a[56:59], v[32:35]
    ds_read2_b32 a[100:101], v244 offset0:48 offset1:49
    v_lshlrev_b32 v5, 2, v2
    s_waitcnt lgkmcnt(7)
    v_mfma_f32_16x16x32_bf16 v[36:39], a[92:95], a[60:63], v[36:39]
    ds_read2_b32 a[102:103], v244 offset0:50 offset1:51
    v_and_b32 v4, 7, v1
    s_waitcnt lgkmcnt(7)
    v_mfma_f32_16x16x32_bf16 v[40:43], a[92:95], a[64:67], v[40:43]
    ds_read2_b32 a[96:97], v245 offset0:48 offset1:49
    v_lshlrev_b32 v6, 8, v1
    s_waitcnt lgkmcnt(7)
    v_mfma_f32_16x16x32_bf16 v[44:47], a[92:95], a[68:71], v[44:47]
    ds_read2_b32 a[98:99], v245 offset0:50 offset1:51
    v_or_b32 v7, 0, v5
    v_mfma_f32_16x16x32_bf16 v[28:31], a[88:91], a[56:59], v[28:31]
    ds_read_b128 a[56:59], v246 offset:160
    v_add_u32 v6, s27, v6
    v_mfma_f32_16x16x32_bf16 v[32:35], a[88:91], a[60:63], v[32:35]
    ds_read_b128 a[60:63], v246 offset:672
    v_xor_b32 v7, v7, v4
    v_mfma_f32_16x16x32_bf16 v[36:39], a[88:91], a[64:67], v[36:39]
    ds_read_b128 a[64:67], v246 offset:1184
    v_lshl_add_u32 v60, v7, 4, v6
    v_mfma_f32_16x16x32_bf16 v[40:43], a[88:91], a[68:71], v[40:43]
    ds_read_b128 a[68:71], v246 offset:1696
    v_or_b32 v7, 1, v5
    s_waitcnt lgkmcnt(11)
    v_mfma_f32_16x16x32_bf16 v[44:47], a[88:91], a[72:75], v[44:47]
    ds_read2st64_b32 v[12:13], v210 offset0:0 offset1:1
    v_xor_b32 v7, v7, v4
    v_mfma_f32_16x16x32_bf16 v[48:51], a[92:95], a[72:75], v[48:51]
    ds_read_b128 a[72:75], v246 offset:2208
    v_lshl_add_u32 v61, v7, 4, v6
    s_waitcnt lgkmcnt(12)
    v_mfma_f32_16x16x32_bf16 v[48:51], a[88:91], a[76:79], v[48:51]
    ds_read2st64_b32 v[14:15], v210 offset0:2 offset1:3
    v_or_b32 v7, 2, v5
    v_mfma_f32_16x16x32_bf16 v[52:55], a[92:95], a[76:79], v[52:55]
    ds_read_b128 a[76:79], v246 offset:2720
    v_xor_b32 v7, v7, v4
    s_waitcnt lgkmcnt(13)
    v_mfma_f32_16x16x32_bf16 v[52:55], a[88:91], a[80:83], v[52:55]
    ds_read2st64_b32 v[16:17], v210 offset0:16 offset1:17
    v_lshl_add_u32 v62, v7, 4, v6
    v_mfma_f32_16x16x32_bf16 v[56:59], a[92:95], a[80:83], v[56:59]
    ds_read_b128 a[80:83], v246 offset:3232
    v_or_b32 v7, 3, v5
    s_waitcnt lgkmcnt(14)
    v_mfma_f32_16x16x32_bf16 v[56:59], a[88:91], a[84:87], v[56:59]
    ds_read_b128 a[84:87], v246 offset:3744
    v_xor_b32 v7, v7, v4
    s_waitcnt lgkmcnt(10)
    v_mfma_f32_16x16x32_bf16 v[32:35], a[100:103], a[56:59], v[32:35]
    ds_read2_b32 a[92:93], v244 offset0:32 offset1:33
    v_lshl_add_u32 v63, v7, 4, v6
    s_waitcnt lgkmcnt(10)
    v_mfma_f32_16x16x32_bf16 v[36:39], a[100:103], a[60:63], v[36:39]
    ds_read2_b32 a[94:95], v244 offset0:34 offset1:35
    v_lshrrev_b32 v8, 2, v0
    s_waitcnt lgkmcnt(10)
    v_mfma_f32_16x16x32_bf16 v[40:43], a[100:103], a[64:67], v[40:43]
    ds_read2_b32 a[88:89], v245 offset0:32 offset1:33
    v_lshrrev_b32 v9, 6, v0
    s_waitcnt lgkmcnt(10)
    v_mfma_f32_16x16x32_bf16 v[44:47], a[100:103], a[68:71], v[44:47]
    ds_read2_b32 a[90:91], v245 offset0:34 offset1:35
    v_xor_b32 v9, v8, v9
    s_waitcnt lgkmcnt(9)
    v_mfma_f32_16x16x32_bf16 v[48:51], a[100:103], a[72:75], v[48:51]
    ds_read2st64_b32 v[18:19], v210 offset0:18 offset1:19
    v_and_b32 v8, 3, v0
    v_mfma_f32_16x16x32_bf16 v[28:31], a[96:99], a[56:59], v[28:31]
    ds_read_b128 a[56:59], v246 offset:96
    v_lshlrev_b32 v154, 16, v12
    v_mfma_f32_16x16x32_bf16 v[32:35], a[96:99], a[60:63], v[32:35]
    ds_read_b128 a[60:63], v246 offset:608
    v_lshlrev_b32 v155, 16, v13
    v_mfma_f32_16x16x32_bf16 v[36:39], a[96:99], a[64:67], v[36:39]
    ds_read_b128 a[64:67], v246 offset:1120
    s_waitcnt lgkmcnt(10)
    v_lshlrev_b32 v156, 16, v16
    v_mfma_f32_16x16x32_bf16 v[40:43], a[96:99], a[68:71], v[40:43]
    ds_read_b128 a[68:71], v246 offset:1632
    v_lshlrev_b32 v157, 16, v17
    v_mfma_f32_16x16x32_bf16 v[44:47], a[96:99], a[72:75], v[44:47]
    ds_read_b128 a[72:75], v246 offset:2144
    v_lshlrev_b32 v166, 16, v14
    v_mfma_f32_16x16x32_bf16 v[48:51], a[96:99], a[76:79], v[48:51]
    ds_read2st64_b32 v[20:21], v209 offset0:0 offset1:1
    v_lshlrev_b32 v167, 16, v15
    v_mfma_f32_16x16x32_bf16 v[52:55], a[100:103], a[76:79], v[52:55]
    ds_read_b128 a[76:79], v246 offset:2656
    s_waitcnt lgkmcnt(7)
    v_lshlrev_b32 v168, 16, v18
    v_mfma_f32_16x16x32_bf16 v[52:55], a[96:99], a[80:83], v[52:55]
    ds_read2st64_b32 v[22:23], v209 offset0:2 offset1:3
    v_lshlrev_b32 v169, 16, v19
    v_mfma_f32_16x16x32_bf16 v[56:59], a[100:103], a[80:83], v[56:59]
    ds_read_b128 a[80:83], v246 offset:3168
    v_and_b32 v178, 0xffff0000, v12
    v_mfma_f32_16x16x32_bf16 v[56:59], a[96:99], a[84:87], v[56:59]
    ds_read_b128 a[84:87], v246 offset:3680
    v_and_b32 v179, 0xffff0000, v13
    s_waitcnt lgkmcnt(9)
    v_mfma_f32_16x16x32_bf16 v[32:35], a[92:95], a[56:59], v[32:35]
    ds_read2_b32 a[100:101], v244 offset0:16 offset1:17
    v_and_b32 v180, 0xffff0000, v16
    s_waitcnt lgkmcnt(9)
    v_mfma_f32_16x16x32_bf16 v[36:39], a[92:95], a[60:63], v[36:39]
    ds_read2_b32 a[102:103], v244 offset0:18 offset1:19
    v_and_b32 v181, 0xffff0000, v17
    s_waitcnt lgkmcnt(9)
    v_mfma_f32_16x16x32_bf16 v[40:43], a[92:95], a[64:67], v[40:43]
    ds_read2_b32 a[96:97], v245 offset0:16 offset1:17
    s_waitcnt lgkmcnt(7)
    v_and_b32 v150, 0xffff0000, v20
    v_mfma_f32_16x16x32_bf16 v[44:47], a[92:95], a[68:71], v[44:47]
    ds_read2_b32 a[98:99], v245 offset0:18 offset1:19
    v_and_b32 v151, 0xffff0000, v21
    v_mfma_f32_16x16x32_bf16 v[48:51], a[92:95], a[72:75], v[48:51]
    ds_read2st64_b32 v[24:25], v209 offset0:16 offset1:17
    s_waitcnt lgkmcnt(7)
    v_and_b32 v162, 0xffff0000, v22
    v_mfma_f32_16x16x32_bf16 v[52:55], a[92:95], a[76:79], v[52:55]
    ds_read2st64_b32 v[26:27], v209 offset0:18 offset1:19
    v_and_b32 v163, 0xffff0000, v23
    v_mfma_f32_16x16x32_bf16 v[28:31], a[88:91], a[56:59], v[28:31]
    ds_read_b128 a[56:59], v246 offset:32
    v_lshlrev_b32 v174, 16, v20
    v_mfma_f32_16x16x32_bf16 v[32:35], a[88:91], a[60:63], v[32:35]
    ds_read_b128 a[60:63], v246 offset:544
    v_lshlrev_b32 v175, 16, v21
    v_mfma_f32_16x16x32_bf16 v[36:39], a[88:91], a[64:67], v[36:39]
    ds_read_b128 a[64:67], v246 offset:1056
    v_and_b32 v190, 0xffff0000, v14
    v_mfma_f32_16x16x32_bf16 v[40:43], a[88:91], a[68:71], v[40:43]
    ds_read_b128 a[68:71], v246 offset:1568
    v_and_b32 v191, 0xffff0000, v15
    v_mfma_f32_16x16x32_bf16 v[44:47], a[88:91], a[72:75], v[44:47]
    ds_read_b128 a[72:75], v246 offset:2080
    v_and_b32 v192, 0xffff0000, v18
    v_mfma_f32_16x16x32_bf16 v[48:51], a[88:91], a[76:79], v[48:51]
    ds_read_b128 a[76:79], v246 offset:2592
    s_waitcnt lgkmcnt(7)
    v_and_b32 v152, 0xffff0000, v24
    v_mfma_f32_16x16x32_bf16 v[52:55], a[88:91], a[80:83], v[52:55]
    v_and_b32 v153, 0xffff0000, v25
    s_waitcnt lgkmcnt(6)
    v_and_b32 v164, 0xffff0000, v26
    v_mfma_f32_16x16x32_bf16 v[56:59], a[92:95], a[80:83], v[56:59]
    ds_read_b128 a[80:83], v246 offset:3104
    v_and_b32 v165, 0xffff0000, v27
    v_mfma_f32_16x16x32_bf16 v[56:59], a[88:91], a[84:87], v[56:59]
    ds_read_b128 a[84:87], v246 offset:3616
    v_lshlrev_b32 v176, 16, v24
    s_waitcnt lgkmcnt(7)
    v_mfma_f32_16x16x32_bf16 v[32:35], a[100:103], a[56:59], v[32:35]
    v_lshlrev_b32 v177, 16, v25
    v_and_b32 v193, 0xffff0000, v19
    s_waitcnt lgkmcnt(6)
    v_mfma_f32_16x16x32_bf16 v[36:39], a[100:103], a[60:63], v[36:39]
    v_lshlrev_b32 v186, 16, v22
    v_lshlrev_b32 v187, 16, v23
    s_waitcnt lgkmcnt(5)
    v_mfma_f32_16x16x32_bf16 v[40:43], a[100:103], a[64:67], v[40:43]
    v_lshlrev_b32 v188, 16, v26
    v_lshlrev_b32 v189, 16, v27
    s_waitcnt lgkmcnt(4)
    v_mfma_f32_16x16x32_bf16 v[44:47], a[100:103], a[68:71], v[44:47]
    v_lshlrev_b32 v8, 2, v8
    v_sub_f32 v160, v154, v150
    s_waitcnt lgkmcnt(3)
    v_mfma_f32_16x16x32_bf16 v[48:51], a[100:103], a[72:75], v[48:51]
    v_add_f32 v158, v156, v152
    v_sub_f32 v161, v155, v151
    s_waitcnt lgkmcnt(2)
    v_mfma_f32_16x16x32_bf16 v[52:55], a[100:103], a[76:79], v[52:55]
    v_add_f32 v159, v157, v153
    v_sub_f32 v172, v166, v162
    s_waitcnt lgkmcnt(1)
    v_mfma_f32_16x16x32_bf16 v[56:59], a[100:103], a[80:83], v[56:59]
    v_add_f32 v170, v168, v164
    v_sub_f32 v173, v167, v163
    v_mfma_f32_16x16x32_bf16 v[28:31], a[96:99], a[56:59], v[28:31]
    v_add_f32 v171, v169, v165
    v_sub_f32 v184, v178, v174
    v_mfma_f32_16x16x32_bf16 v[32:35], a[96:99], a[60:63], v[32:35]
    v_add_f32 v182, v180, v176
    v_sub_f32 v185, v179, v175
    v_mfma_f32_16x16x32_bf16 v[36:39], a[96:99], a[64:67], v[36:39]
    v_add_f32 v183, v181, v177
    v_sub_f32 v196, v190, v186
    v_mfma_f32_16x16x32_bf16 v[40:43], a[96:99], a[68:71], v[40:43]
    v_add_f32 v194, v192, v188
    s_nop 0
    v_cvt_pk_bf16_f32 v64, v28, v32
    v_mfma_f32_16x16x32_bf16 v[44:47], a[96:99], a[72:75], v[44:47]
    v_cvt_pk_bf16_f32 v68, v29, v33
    v_cvt_pk_bf16_f32 v72, v30, v34
    v_mfma_f32_16x16x32_bf16 v[48:51], a[96:99], a[76:79], v[48:51]
    v_cvt_pk_bf16_f32 v76, v31, v35
    v_cvt_pk_bf16_f32 v65, v36, v40
    v_mfma_f32_16x16x32_bf16 v[52:55], a[96:99], a[80:83], v[52:55]
    v_cvt_pk_bf16_f32 v69, v37, v41
    v_cvt_pk_bf16_f32 v73, v38, v42
    s_waitcnt lgkmcnt(0)
    v_mfma_f32_16x16x32_bf16 v[56:59], a[96:99], a[84:87], v[56:59]
    v_cvt_pk_bf16_f32 v77, v39, v43
    v_cvt_pk_bf16_f32 v66, v44, v48
    v_cvt_pk_bf16_f32 v70, v45, v49
    v_cvt_pk_bf16_f32 v74, v46, v50
    v_cvt_pk_bf16_f32 v78, v47, v51
    v_sub_f32 v197, v191, v187
    v_add_f32 v195, v193, v189
    v_lshl_add_u32 v9, v9, 4, v8
    s_lshl_b32 s28, s46, 6
    v_cvt_pk_bf16_f32 v67, v52, v56
    ds_write_b128 v60, v[64:67]
    v_cvt_pk_bf16_f32 v71, v53, v57
    v_cvt_pk_bf16_f32 v75, v54, v58
    v_cvt_pk_bf16_f32 v79, v55, v59
    v_fmac_f32 v150, v160, v216
    ds_write_b128 v61, v[68:71]
    v_fma_f32 v152, v158, v216, -v152
    v_fma_f32 v154, -v160, v216, v154
    v_fma_f32 v156, -v158, v216, v156
    v_fmac_f32 v151, v161, v216
    v_fma_f32 v153, v159, v216, -v153
    v_fma_f32 v155, -v161, v216, v155
    ds_write_b128 v62, v[72:75]
    v_fma_f32 v157, -v159, v216, v157
    v_fmac_f32 v162, v172, v216
    v_fma_f32 v164, v170, v216, -v164
    v_fma_f32 v166, -v172, v216, v166
    v_fma_f32 v168, -v170, v216, v168
    ds_write_b128 v63, v[76:79]
    v_fmac_f32 v163, v173, v216
    v_fma_f32 v165, v171, v216, -v165
    v_fma_f32 v167, -v173, v216, v167
    v_fma_f32 v169, -v171, v216, v169
    v_fmac_f32 v174, v184, v218
    v_fma_f32 v176, v182, v218, -v176
    v_fma_f32 v178, -v184, v218, v178
    v_fma_f32 v180, -v182, v218, v180
    v_fmac_f32 v175, v185, v218
    v_fma_f32 v177, v183, v218, -v177
    v_fma_f32 v179, -v185, v218, v179
    v_fma_f32 v181, -v183, v218, v181
    v_fmac_f32 v186, v196, v218
    v_fma_f32 v188, v194, v218, -v188
    v_fma_f32 v190, -v196, v218, v190
    v_fma_f32 v192, -v194, v218, v192
    v_fmac_f32 v187, v197, v218
    v_fma_f32 v189, v195, v218, -v189
    v_fma_f32 v191, -v197, v218, v191
    v_fma_f32 v193, -v195, v218, v193
    v_add_u32 v9, 0x8000, v9
    s_add_u32 s28, s28, 0xd80000
    s_add_u32 s29, s28, 0x104000
    v_mul_f32 v158, -v158, v217
    v_mul_f32 v160, v160, v217
    v_mul_f32 v159, -v159, v217
    v_mul_f32 v161, v161, v217
    v_mul_f32 v170, -v170, v217
    v_mul_f32 v172, v172, v217
    v_mul_f32 v171, -v171, v217
    v_mul_f32 v173, v173, v217
    v_mul_f32 v182, -v182, v219
    v_mul_f32 v184, v184, v219
    v_mul_f32 v183, -v183, v219
    v_mul_f32 v185, v185, v219
    v_mul_f32 v194, -v194, v219
    v_mul_f32 v196, v196, v219
    v_mul_f32 v195, -v195, v219
    v_mul_f32 v197, v197, v219
    v_xor_b32 v10, 64, v9
    s_add_u32 s30, s29, 0x104000
    s_add_u32 s31, s30, 0x104000
    s_cmp_eq_u32 s51, 0
    s_cbranch_scc1 k_p2x
    s_mov_b32 s57, 0x20000
    s_waitcnt vmcnt(0)
    s_branch tc_5
tl_4:
    buffer_load_dwordx4 v[132:135], v208, s[4:7], s22 offen sc1
    buffer_load_dwordx4 v[136:139], v208, s[4:7], s22 offen offset:1024 sc1
    buffer_load_dwordx4 v[140:143], v208, s[4:7], s22 offen offset:2048 sc1
    buffer_load_dwordx4 v[144:147], v208, s[4:7], s22 offen offset:3072 sc1
    s_waitcnt vmcnt(0)
tc_5:
    v_xor_b32 v4, v132, v199
    v_xor_b32 v5, v133, v200
    v_xor_b32 v6, v134, v201
    v_xor_b32 v7, v135, v202
    v_bitop3_b32 v4, v4, v136, v199 bitop3:0xf6
    v_bitop3_b32 v5, v5, v137, v200 bitop3:0xf6
    v_bitop3_b32 v6, v6, v138, v201 bitop3:0xf6
    v_bitop3_b32 v7, v7, v139, v202 bitop3:0xf6
    v_bitop3_b32 v4, v4, v140, v199 bitop3:0xf6
    v_bitop3_b32 v5, v5, v141, v200 bitop3:0xf6
    v_bitop3_b32 v6, v6, v142, v201 bitop3:0xf6
    v_bitop3_b32 v7, v7, v143, v202 bitop3:0xf6
    v_bitop3_b32 v4, v4, v144, v199 bitop3:0xf6
    v_bitop3_b32 v5, v5, v145, v200 bitop3:0xf6
    v_bitop3_b32 v6, v6, v146, v201 bitop3:0xf6
    v_bitop3_b32 v7, v7, v147, v202 bitop3:0xf6
    v_or3_b32 v4, v4, v5, v6
    v_or_b32 v4, v4, v7
    v_and_b32 v4, s55, v4
    s_nop 1
    v_or_b32_dpp v4, v4, v4 quad_perm:[1,0,3,2] row_mask:0xf bank_mask:0xf
    s_nop 1
    v_or_b32_dpp v4, v4, v4 quad_perm:[2,3,0,1] row_mask:0xf bank_mask:0xf
    v_cmp_ne_u32 vcc, 0, v4
    s_nop 0
    s_and_b64 exec, exec, vcc
    s_cbranch_scc0 td_6
    s_sub_u32 s57, s57, 1
    s_cbranch_scc0 tl_4
td_6:
    s_mov_b64 exec, -1
    ds_write_b128 v206, v[132:135] offset:0
    ds_write_b128 v206, v[136:139] offset:1024
    ds_write_b128 v206, v[140:143] offset:2048
    ds_write_b128 v206, v[144:147] offset:3072
    s_lshl_b32 s36, s46, 6
    s_add_u32 s36, s36, 0x900000
    s_add_u32 s37, s36, 0x104000
    s_add_u32 s38, s37, 0x104000
    s_add_u32 s39, s38, 0x104000
    s_waitcnt lgkmcnt(0)
    s_barrier
    ds_read_b64 v[12:13], v214 offset:0
    ds_read_b64 v[16:17], v214 offset:1024
    ds_read_b64 v[14:15], v214 offset:2048
    ds_read_b64 v[18:19], v214 offset:3072
    ds_read_b64 v[20:21], v215 offset:0
    ds_read_b64 v[24:25], v215 offset:1024
    ds_read_b64 v[22:23], v215 offset:2048
    ds_read_b64 v[26:27], v215 offset:3072
    ds_read2st64_b32 v[132:133], v9 offset0:0 offset1:77
    ds_read2st64_b32 v[134:135], v9 offset0:154 offset1:231
    ds_read2st64_b32 v[136:137], v10 offset0:4 offset1:81
    ds_read2st64_b32 v[138:139], v10 offset0:158 offset1:235
    s_waitcnt lgkmcnt(10)
    v_swap_b32 v13, v16
    ds_read2st64_b32 v[140:141], v9 offset0:8 offset1:85
    s_waitcnt lgkmcnt(9)
    v_swap_b32 v15, v18
    ds_read2st64_b32 v[142:143], v9 offset0:162 offset1:239
    s_waitcnt lgkmcnt(8)
    v_swap_b32 v21, v24
    v_mfma_f32_16x16x32_bf16 v[32:35], v[12:15], a[136:139], 0
    s_waitcnt lgkmcnt(6)
    v_swap_b32 v23, v26
    v_mfma_f32_16x16x32_bf16 v[36:39], v[12:15], a[140:143], 0
    ds_read2st64_b32 v[144:145], v10 offset0:12 offset1:89
    s_waitcnt lgkmcnt(6)
    v_bfi_b32 v132, s55, v199, v132
    v_mfma_f32_16x16x32_bf16 v[40:43], v[16:19], a[136:139], 0
    ds_read2st64_b32 v[146:147], v10 offset0:166 offset1:243
    v_bfi_b32 v133, s55, v200, v133
    v_mfma_f32_16x16x32_bf16 v[44:47], v[16:19], a[140:143], 0
    s_waitcnt lgkmcnt(6)
    v_bfi_b32 v134, s55, v201, v134
    v_bfi_b32 v135, s55, v202, v135
    v_mfma_f32_16x16x32_bf16 v[48:51], v[20:23], a[136:139], 0
    buffer_store_dwordx4 v[132:135], v211, s[4:7], s28 offen sc1
    v_mfma_f32_16x16x32_bf16 v[52:55], v[20:23], a[140:143], 0
    s_waitcnt lgkmcnt(5)
    v_bfi_b32 v136, s55, v199, v136
    v_bfi_b32 v137, s55, v200, v137
    v_mfma_f32_16x16x32_bf16 v[56:59], v[24:27], a[136:139], 0
    s_waitcnt lgkmcnt(4)
    v_bfi_b32 v138, s55, v201, v138
    v_bfi_b32 v139, s55, v202, v139
    v_mfma_f32_16x16x32_bf16 v[60:63], v[24:27], a[140:143], 0
    buffer_store_dwordx4 v[136:139], v211, s[4:7], s29 offen sc1
    s_waitcnt lgkmcnt(3)
    v_bfi_b32 v140, s55, v199, v140
    v_pk_mul_f32 v[72:73], v[32:33], v[220:221]
    v_pk_mul_f32 v[74:75], v[36:37], v[220:221]
    v_pk_mul_f32 v[76:77], v[34:35], v[222:223]
    v_pk_mul_f32 v[78:79], v[38:39], v[222:223]
    v_pk_mul_f32 v[80:81], v[40:41], v[220:221]
    v_pk_mul_f32 v[82:83], v[44:45], v[220:221]
    v_pk_mul_f32 v[84:85], v[42:43], v[222:223]
    v_pk_mul_f32 v[86:87], v[46:47], v[222:223]
    v_pk_fma_f32 v[72:73], v[36:37], v[224:225], v[72:73]
    v_pk_fma_f32 v[74:75], v[32:33], v[224:225], v[74:75] neg_lo:[1,0,0] neg_hi:[1,0,0]
    v_pk_fma_f32 v[76:77], v[38:39], v[226:227], v[76:77]
    v_pk_fma_f32 v[78:79], v[34:35], v[226:227], v[78:79] neg_lo:[1,0,0] neg_hi:[1,0,0]
    v_pk_fma_f32 v[80:81], v[44:45], v[224:225], v[80:81]
    v_pk_fma_f32 v[82:83], v[40:41], v[224:225], v[82:83] neg_lo:[1,0,0] neg_hi:[1,0,0]
    v_pk_fma_f32 v[84:85], v[46:47], v[226:227], v[84:85]
    v_pk_fma_f32 v[86:87], v[42:43], v[226:227], v[86:87] neg_lo:[1,0,0] neg_hi:[1,0,0]
    v_cvt_pk_bf16_f32 v12, v72, v74
    v_cvt_pk_bf16_f32 v13, v73, v75
    v_cvt_pk_bf16_f32 v14, v76, v78
    v_cvt_pk_bf16_f32 v15, v77, v79
    v_cvt_pk_bf16_f32 v16, v80, v82
    v_cvt_pk_bf16_f32 v17, v81, v83
    v_cvt_pk_bf16_f32 v18, v84, v86
    v_cvt_pk_bf16_f32 v19, v85, v87
    v_pk_mul_f32 v[88:89], v[48:49], v[220:221]
    v_pk_mul_f32 v[90:91], v[52:53], v[220:221]
    v_pk_mul_f32 v[92:93], v[50:51], v[222:223]
    v_pk_mul_f32 v[94:95], v[54:55], v[222:223]
    v_pk_mul_f32 v[96:97], v[56:57], v[220:221]
    v_pk_mul_f32 v[98:99], v[60:61], v[220:221]
    v_pk_mul_f32 v[100:101], v[58:59], v[222:223]
    v_pk_mul_f32 v[102:103], v[62:63], v[222:223]
    v_pk_fma_f32 v[88:89], v[52:53], v[224:225], v[88:89]
    v_pk_fma_f32 v[90:91], v[48:49], v[224:225], v[90:91] neg_lo:[1,0,0] neg_hi:[1,0,0]
    v_pk_fma_f32 v[92:93], v[54:55], v[226:227], v[92:93]
    v_pk_fma_f32 v[94:95], v[50:51], v[226:227], v[94:95] neg_lo:[1,0,0] neg_hi:[1,0,0]
    v_pk_fma_f32 v[96:97], v[60:61], v[224:225], v[96:97]
    v_pk_fma_f32 v[98:99], v[56:57], v[224:225], v[98:99] neg_lo:[1,0,0] neg_hi:[1,0,0]
    v_pk_fma_f32 v[100:101], v[62:63], v[226:227], v[100:101]
    v_pk_fma_f32 v[102:103], v[58:59], v[226:227], v[102:103] neg_lo:[1,0,0] neg_hi:[1,0,0]
    v_cvt_pk_bf16_f32 v20, v88, v90
    v_cvt_pk_bf16_f32 v21, v89, v91
    v_cvt_pk_bf16_f32 v22, v92, v94
    v_cvt_pk_bf16_f32 v23, v93, v95
    v_cvt_pk_bf16_f32 v24, v96, v98
    v_cvt_pk_bf16_f32 v25, v97, v99
    v_cvt_pk_bf16_f32 v26, v100, v102
    v_cvt_pk_bf16_f32 v27, v101, v103
    v_mfma_f32_16x16x32_bf16 v[32:35], v[248:251], v[12:15], 0
    v_bfi_b32 v141, s55, v200, v141
    s_waitcnt lgkmcnt(2)
    v_bfi_b32 v142, s55, v201, v142
    v_mfma_f32_16x16x32_bf16 v[36:39], v[252:255], v[12:15], 0
    v_bfi_b32 v143, s55, v202, v143
    buffer_store_dwordx4 v[140:143], v211, s[4:7], s30 offen sc1
    s_nop 1
    v_pk_mul_f32 v[72:73], v[150:151], v[32:33]
    v_pk_mul_f32 v[80:81], v[162:163], v[34:35]
    v_mfma_f32_16x16x32_bf16 v[40:43], v[248:251], v[16:19], 0
    s_waitcnt lgkmcnt(1)
    v_bfi_b32 v144, s55, v199, v144
    v_bfi_b32 v145, s55, v200, v145
    v_mfma_f32_16x16x32_bf16 v[44:47], v[252:255], v[16:19], 0
    s_waitcnt lgkmcnt(0)
    v_bfi_b32 v146, s55, v201, v146
    v_bfi_b32 v147, s55, v202, v147
    v_mfma_f32_16x16x32_bf16 v[48:51], v[248:251], v[20:23], 0
    buffer_store_dwordx4 v[144:147], v211, s[4:7], s31 offen sc1
    v_mfma_f32_16x16x32_bf16 v[52:55], v[252:255], v[20:23], 0
    v_mfma_f32_16x16x32_bf16 v[56:59], v[248:251], v[24:27], 0
    v_mfma_f32_16x16x32_bf16 v[60:63], v[252:255], v[24:27], 0
    v_pk_mul_f32 v[74:75], v[150:151], v[36:37]
    v_pk_mul_f32 v[82:83], v[162:163], v[38:39]
    v_pk_mul_f32 v[88:89], v[174:175], v[40:41]
    v_pk_mul_f32 v[90:91], v[174:175], v[44:45]
    v_pk_mul_f32 v[96:97], v[186:187], v[42:43]
    v_pk_mul_f32 v[98:99], v[186:187], v[46:47]
    v_pk_fma_f32 v[72:73], v[152:153], v[36:37], v[72:73] neg_lo:[1,0,0] neg_hi:[1,0,0]
    v_pk_fma_f32 v[74:75], v[152:153], v[32:33], v[74:75]
    v_pk_fma_f32 v[80:81], v[164:165], v[38:39], v[80:81] neg_lo:[1,0,0] neg_hi:[1,0,0]
    v_pk_fma_f32 v[82:83], v[164:165], v[34:35], v[82:83]
    v_pk_fma_f32 v[88:89], v[176:177], v[44:45], v[88:89] neg_lo:[1,0,0] neg_hi:[1,0,0]
    v_pk_fma_f32 v[90:91], v[176:177], v[40:41], v[90:91]
    v_pk_fma_f32 v[96:97], v[188:189], v[46:47], v[96:97] neg_lo:[1,0,0] neg_hi:[1,0,0]
    v_pk_fma_f32 v[98:99], v[188:189], v[42:43], v[98:99]
    v_pk_fma_f32 v[72:73], v[158:159], v[48:49], v[72:73]
    v_pk_fma_f32 v[74:75], v[158:159], v[52:53], v[74:75]
    v_pk_fma_f32 v[80:81], v[170:171], v[50:51], v[80:81]
    v_pk_fma_f32 v[82:83], v[170:171], v[54:55], v[82:83]
    v_pk_fma_f32 v[88:89], v[182:183], v[56:57], v[88:89]
    v_pk_fma_f32 v[90:91], v[182:183], v[60:61], v[90:91]
    v_pk_fma_f32 v[96:97], v[194:195], v[58:59], v[96:97]
    v_pk_fma_f32 v[98:99], v[194:195], v[62:63], v[98:99]
    v_pk_fma_f32 v[72:73], v[160:161], v[52:53], v[72:73] neg_lo:[1,0,0] neg_hi:[1,0,0]
    v_pk_fma_f32 v[74:75], v[160:161], v[48:49], v[74:75]
    v_pk_fma_f32 v[80:81], v[172:173], v[54:55], v[80:81] neg_lo:[1,0,0] neg_hi:[1,0,0]
    v_pk_fma_f32 v[82:83], v[172:173], v[50:51], v[82:83]
    v_pk_fma_f32 v[88:89], v[184:185], v[60:61], v[88:89] neg_lo:[1,0,0] neg_hi:[1,0,0]
    v_pk_fma_f32 v[90:91], v[184:185], v[56:57], v[90:91]
    v_pk_fma_f32 v[96:97], v[196:197], v[62:63], v[96:97] neg_lo:[1,0,0] neg_hi:[1,0,0]
    v_pk_fma_f32 v[98:99], v[196:197], v[58:59], v[98:99]
    v_pk_mul_f32 v[76:77], v[154:155], v[48:49]
    v_pk_mul_f32 v[78:79], v[154:155], v[52:53]
    v_pk_mul_f32 v[84:85], v[166:167], v[50:51]
    v_pk_mul_f32 v[86:87], v[166:167], v[54:55]
    v_pk_mul_f32 v[92:93], v[178:179], v[56:57]
    v_pk_mul_f32 v[94:95], v[178:179], v[60:61]
    v_pk_mul_f32 v[100:101], v[190:191], v[58:59]
    v_pk_mul_f32 v[102:103], v[190:191], v[62:63]
    v_cvt_pk_bf16_f32 v12, v72, -v74
    v_cvt_pk_bf16_f32 v13, v73, -v75
    v_cvt_pk_bf16_f32 v14, v80, -v82
    v_cvt_pk_bf16_f32 v15, v81, -v83
    v_cvt_pk_bf16_f32 v16, v88, -v90
    v_cvt_pk_bf16_f32 v17, v89, -v91
    v_cvt_pk_bf16_f32 v18, v96, -v98
    v_cvt_pk_bf16_f32 v19, v97, -v99
    v_pk_fma_f32 v[76:77], v[156:157], v[52:53], v[76:77] neg_lo:[1,0,0] neg_hi:[1,0,0]
    v_pk_fma_f32 v[78:79], v[156:157], v[48:49], v[78:79]
    v_pk_fma_f32 v[84:85], v[168:169], v[54:55], v[84:85] neg_lo:[1,0,0] neg_hi:[1,0,0]
    v_pk_fma_f32 v[86:87], v[168:169], v[50:51], v[86:87]
    v_pk_fma_f32 v[92:93], v[180:181], v[60:61], v[92:93] neg_lo:[1,0,0] neg_hi:[1,0,0]
    v_pk_fma_f32 v[94:95], v[180:181], v[56:57], v[94:95]
    v_pk_fma_f32 v[100:101], v[192:193], v[62:63], v[100:101] neg_lo:[1,0,0] neg_hi:[1,0,0]
    v_pk_fma_f32 v[102:103], v[192:193], v[58:59], v[102:103]
    v_pk_fma_f32 v[76:77], v[158:159], v[32:33], v[76:77] neg_lo:[1,0,0] neg_hi:[1,0,0]
    v_pk_fma_f32 v[78:79], v[158:159], v[36:37], v[78:79] neg_lo:[1,0,0] neg_hi:[1,0,0]
    v_pk_fma_f32 v[84:85], v[170:171], v[34:35], v[84:85] neg_lo:[1,0,0] neg_hi:[1,0,0]
    v_pk_fma_f32 v[86:87], v[170:171], v[38:39], v[86:87] neg_lo:[1,0,0] neg_hi:[1,0,0]
    v_pk_fma_f32 v[92:93], v[182:183], v[40:41], v[92:93] neg_lo:[1,0,0] neg_hi:[1,0,0]
    v_pk_fma_f32 v[94:95], v[182:183], v[44:45], v[94:95] neg_lo:[1,0,0] neg_hi:[1,0,0]
    v_pk_fma_f32 v[100:101], v[194:195], v[42:43], v[100:101] neg_lo:[1,0,0] neg_hi:[1,0,0]
    v_pk_fma_f32 v[102:103], v[194:195], v[46:47], v[102:103] neg_lo:[1,0,0] neg_hi:[1,0,0]
    v_pk_fma_f32 v[76:77], v[160:161], v[36:37], v[76:77]
    v_pk_fma_f32 v[78:79], v[160:161], v[32:33], v[78:79] neg_lo:[1,0,0] neg_hi:[1,0,0]
    v_pk_fma_f32 v[84:85], v[172:173], v[38:39], v[84:85]
    v_pk_fma_f32 v[86:87], v[172:173], v[34:35], v[86:87] neg_lo:[1,0,0] neg_hi:[1,0,0]
    v_pk_fma_f32 v[92:93], v[184:185], v[44:45], v[92:93]
    v_pk_fma_f32 v[94:95], v[184:185], v[40:41], v[94:95] neg_lo:[1,0,0] neg_hi:[1,0,0]
    v_pk_fma_f32 v[100:101], v[196:197], v[46:47], v[100:101]
    v_pk_fma_f32 v[102:103], v[196:197], v[42:43], v[102:103] neg_lo:[1,0,0] neg_hi:[1,0,0]
    v_mfma_f32_16x16x32_bf16 v[32:35], v[12:15], v[248:251], 0
    v_cvt_pk_bf16_f32 v20, v76, -v78
    v_cvt_pk_bf16_f32 v21, v77, -v79
    v_mfma_f32_16x16x32_bf16 v[36:39], v[12:15], v[252:255], 0
    v_cvt_pk_bf16_f32 v22, v84, -v86
    v_cvt_pk_bf16_f32 v23, v85, -v87
    v_mfma_f32_16x16x32_bf16 v[40:43], v[16:19], v[248:251], 0
    v_cvt_pk_bf16_f32 v24, v92, -v94
    v_cvt_pk_bf16_f32 v25, v93, -v95
    v_mfma_f32_16x16x32_bf16 v[44:47], v[16:19], v[252:255], 0
    v_cvt_pk_bf16_f32 v26, v100, -v102
    v_cvt_pk_bf16_f32 v27, v101, -v103
    v_mfma_f32_16x16x32_bf16 v[48:51], v[20:23], v[248:251], 0
    v_mfma_f32_16x16x32_bf16 v[52:55], v[20:23], v[252:255], 0
    v_mfma_f32_16x16x32_bf16 v[56:59], v[24:27], v[248:251], 0
    v_mfma_f32_16x16x32_bf16 v[60:63], v[24:27], v[252:255], 0
    v_pk_mul_f32 v[72:73], v[32:33], v[228:229]
    v_pk_mul_f32 v[74:75], v[36:37], v[228:229]
    v_pk_mul_f32 v[76:77], v[34:35], v[230:231]
    v_pk_mul_f32 v[78:79], v[38:39], v[230:231]
    v_pk_mul_f32 v[80:81], v[40:41], v[228:229]
    v_pk_mul_f32 v[82:83], v[44:45], v[228:229]
    v_pk_mul_f32 v[84:85], v[42:43], v[230:231]
    v_pk_mul_f32 v[86:87], v[46:47], v[230:231]
    v_pk_fma_f32 v[72:73], v[36:37], v[232:233], v[72:73]
    v_pk_fma_f32 v[74:75], v[32:33], v[232:233], v[74:75] neg_lo:[1,0,0] neg_hi:[1,0,0]
    v_pk_fma_f32 v[76:77], v[38:39], v[234:235], v[76:77]
    v_pk_fma_f32 v[78:79], v[34:35], v[234:235], v[78:79] neg_lo:[1,0,0] neg_hi:[1,0,0]
    v_pk_fma_f32 v[80:81], v[44:45], v[232:233], v[80:81]
    v_pk_fma_f32 v[82:83], v[40:41], v[232:233], v[82:83] neg_lo:[1,0,0] neg_hi:[1,0,0]
    v_pk_fma_f32 v[84:85], v[46:47], v[234:235], v[84:85]
    v_pk_fma_f32 v[86:87], v[42:43], v[234:235], v[86:87] neg_lo:[1,0,0] neg_hi:[1,0,0]
    v_cvt_pk_bf16_f32 v12, v72, v74
    v_cvt_pk_bf16_f32 v13, v73, v75
    v_cvt_pk_bf16_f32 v14, v76, v78
    v_cvt_pk_bf16_f32 v15, v77, v79
    v_cvt_pk_bf16_f32 v16, v80, v82
    v_cvt_pk_bf16_f32 v17, v81, v83
    v_cvt_pk_bf16_f32 v18, v84, v86
    v_cvt_pk_bf16_f32 v19, v85, v87
    v_pk_mul_f32 v[88:89], v[48:49], v[228:229]
    v_pk_mul_f32 v[90:91], v[52:53], v[228:229]
    v_pk_mul_f32 v[92:93], v[50:51], v[230:231]
    v_pk_mul_f32 v[94:95], v[54:55], v[230:231]
    v_pk_mul_f32 v[96:97], v[56:57], v[228:229]
    v_pk_mul_f32 v[98:99], v[60:61], v[228:229]
    v_pk_mul_f32 v[100:101], v[58:59], v[230:231]
    v_pk_mul_f32 v[102:103], v[62:63], v[230:231]
    v_pk_fma_f32 v[88:89], v[52:53], v[232:233], v[88:89]
    v_pk_fma_f32 v[90:91], v[48:49], v[232:233], v[90:91] neg_lo:[1,0,0] neg_hi:[1,0,0]
    v_pk_fma_f32 v[92:93], v[54:55], v[234:235], v[92:93]
    v_pk_fma_f32 v[94:95], v[50:51], v[234:235], v[94:95] neg_lo:[1,0,0] neg_hi:[1,0,0]
    v_pk_fma_f32 v[96:97], v[60:61], v[232:233], v[96:97]
    v_pk_fma_f32 v[98:99], v[56:57], v[232:233], v[98:99] neg_lo:[1,0,0] neg_hi:[1,0,0]
    v_pk_fma_f32 v[100:101], v[62:63], v[234:235], v[100:101]
    v_pk_fma_f32 v[102:103], v[58:59], v[234:235], v[102:103] neg_lo:[1,0,0] neg_hi:[1,0,0]
    v_mfma_f32_16x16x32_bf16 v[32:35], a[144:147], v[12:15], 0
    v_cvt_pk_bf16_f32 v20, v88, v90
    v_cvt_pk_bf16_f32 v21, v89, v91
    v_mfma_f32_16x16x32_bf16 v[36:39], a[148:151], v[12:15], 0
    v_cvt_pk_bf16_f32 v22, v92, v94
    v_cvt_pk_bf16_f32 v23, v93, v95
    v_mfma_f32_16x16x32_bf16 v[40:43], a[144:147], v[16:19], 0
    v_cvt_pk_bf16_f32 v24, v96, v98
    v_cvt_pk_bf16_f32 v25, v97, v99
    v_mfma_f32_16x16x32_bf16 v[44:47], a[148:151], v[16:19], 0
    v_cvt_pk_bf16_f32 v26, v100, v102
    s_nop 0
    v_cvt_pk_bf16_f32 v12, v32, v36
    v_cvt_pk_bf16_f32 v14, v33, v37
    v_cvt_pk_bf16_f32 v27, v101, v103
    v_mfma_f32_16x16x32_bf16 v[48:51], a[144:147], v[20:23], 0
    v_cvt_pk_bf16_f32 v16, v34, v38
    v_cvt_pk_bf16_f32 v18, v35, v39
    v_mfma_f32_16x16x32_bf16 v[52:55], a[148:151], v[20:23], 0
    v_cvt_pk_bf16_f32 v13, v40, v44
    ds_write_b64 v212, v[12:13] offset:16384
    v_cvt_pk_bf16_f32 v15, v41, v45
    ds_write_b64 v212, v[14:15] offset:17408
    v_mfma_f32_16x16x32_bf16 v[56:59], a[144:147], v[24:27], 0
    v_cvt_pk_bf16_f32 v17, v42, v46
    ds_write_b64 v212, v[16:17] offset:18432
    v_mfma_f32_16x16x32_bf16 v[60:63], a[148:151], v[24:27], 0
    v_cvt_pk_bf16_f32 v19, v43, v47
    ds_write_b64 v212, v[18:19] offset:19456
    v_cvt_pk_bf16_f32 v20, v48, v52
    v_cvt_pk_bf16_f32 v22, v49, v53
    v_cvt_pk_bf16_f32 v24, v50, v54
    s_nop 2
    v_cvt_pk_bf16_f32 v21, v56, v60
    ds_write_b64 v213, v[20:21] offset:16384
    v_cvt_pk_bf16_f32 v23, v57, v61
    ds_write_b64 v213, v[22:23] offset:17408
    v_cvt_pk_bf16_f32 v25, v58, v62
    ds_write_b64 v213, v[24:25] offset:18432
    v_cvt_pk_bf16_f32 v26, v51, v55
    v_cvt_pk_bf16_f32 v27, v59, v63
    ds_write_b64 v213, v[26:27] offset:19456
    s_waitcnt lgkmcnt(0)
    s_barrier
    ds_read_b128 v[32:35], v240 offset:16384
    ds_read_b128 v[36:39], v240 offset:20480
    ds_read_b128 v[40:43], v240 offset:24576
    ds_read_b128 v[44:47], v240 offset:28672
    s_waitcnt lgkmcnt(3)
    v_bfi_b32 v32, s55, v199, v32
    v_bfi_b32 v33, s55, v200, v33
    v_bfi_b32 v34, s55, v201, v34
    v_bfi_b32 v35, s55, v202, v35
    buffer_store_dwordx4 v[32:35], v211, s[4:7], s36 offen sc1
    s_waitcnt lgkmcnt(2)
    v_bfi_b32 v36, s55, v199, v36
    v_bfi_b32 v37, s55, v200, v37
    v_bfi_b32 v38, s55, v201, v38
    v_bfi_b32 v39, s55, v202, v39
    buffer_store_dwordx4 v[36:39], v211, s[4:7], s37 offen sc1
    s_waitcnt lgkmcnt(1)
    v_bfi_b32 v40, s55, v199, v40
    v_bfi_b32 v41, s55, v200, v41
    v_bfi_b32 v42, s55, v201, v42
    v_bfi_b32 v43, s55, v202, v43
    buffer_store_dwordx4 v[40:43], v211, s[4:7], s38 offen sc1
    s_waitcnt lgkmcnt(0)
    v_bfi_b32 v44, s55, v199, v44
    v_bfi_b32 v45, s55, v200, v45
    v_bfi_b32 v46, s55, v201, v46
    v_bfi_b32 v47, s55, v202, v47
    buffer_store_dwordx4 v[44:47], v211, s[4:7], s39 offen sc1
    s_branch k_p2done
k_p2x:
    s_mov_b32 s57, 0x20000
    s_waitcnt vmcnt(0)
    s_branch tc_8
tl_7:
    buffer_load_dwordx4 v[132:135], v208, s[4:7], s22 offen sc1
    buffer_load_dwordx4 v[136:139], v208, s[4:7], s22 offen offset:1024 sc1
    buffer_load_dwordx4 v[140:143], v208, s[4:7], s22 offen offset:2048 sc1
    buffer_load_dwordx4 v[144:147], v208, s[4:7], s22 offen offset:3072 sc1
    buffer_load_dwordx4 v[116:119], v11, s[4:7], s23 offen sc1
    buffer_load_dwordx4 v[120:123], v11, s[4:7], s23 offen offset:256 sc1
    buffer_load_dwordx4 v[124:127], v11, s[4:7], s23 offen offset:512 sc1
    buffer_load_dwordx4 v[128:131], v11, s[4:7], s23 offen offset:768 sc1
    s_waitcnt vmcnt(0)
tc_8:
    v_xor_b32 v4, v132, v199
    v_xor_b32 v5, v133, v200
    v_xor_b32 v6, v134, v201
    v_xor_b32 v7, v135, v202
    v_bitop3_b32 v4, v4, v136, v199 bitop3:0xf6
    v_bitop3_b32 v5, v5, v137, v200 bitop3:0xf6
    v_bitop3_b32 v6, v6, v138, v201 bitop3:0xf6
    v_bitop3_b32 v7, v7, v139, v202 bitop3:0xf6
    v_bitop3_b32 v4, v4, v140, v199 bitop3:0xf6
    v_bitop3_b32 v5, v5, v141, v200 bitop3:0xf6
    v_bitop3_b32 v6, v6, v142, v201 bitop3:0xf6
    v_bitop3_b32 v7, v7, v143, v202 bitop3:0xf6
    v_bitop3_b32 v4, v4, v144, v199 bitop3:0xf6
    v_bitop3_b32 v5, v5, v145, v200 bitop3:0xf6
    v_bitop3_b32 v6, v6, v146, v201 bitop3:0xf6
    v_bitop3_b32 v7, v7, v147, v202 bitop3:0xf6
    v_or3_b32 v4, v4, v5, v6
    v_or_b32 v4, v4, v7
    v_and_b32 v4, s55, v4
    v_xor_b32 v5, s56, v118
    v_or_b32 v4, v4, v5
    v_xor_b32 v5, s56, v122
    v_or_b32 v4, v4, v5
    v_xor_b32 v5, s56, v126
    v_or_b32 v4, v4, v5
    v_xor_b32 v5, s56, v130
    v_or_b32 v4, v4, v5
    s_nop 1
    v_or_b32_dpp v4, v4, v4 quad_perm:[1,0,3,2] row_mask:0xf bank_mask:0xf
    s_nop 1
    v_or_b32_dpp v4, v4, v4 quad_perm:[2,3,0,1] row_mask:0xf bank_mask:0xf
    v_cmp_ne_u32 vcc, 0, v4
    s_nop 0
    s_and_b64 exec, exec, vcc
    s_cbranch_scc0 td_9
    s_sub_u32 s57, s57, 1
    s_cbranch_scc0 tl_7
td_9:
    s_mov_b64 exec, -1
    ds_write_b128 v206, v[132:135] offset:0
    ds_write_b128 v206, v[136:139] offset:1024
    ds_write_b128 v206, v[140:143] offset:2048
    ds_write_b128 v206, v[144:147] offset:3072
    v_mov_b32 v28, v116
    v_lshlrev_b32 v104, 16, v117
    v_and_b32 v108, 0xffff0000, v117
    v_mov_b32 v29, v120
    v_lshlrev_b32 v105, 16, v121
    v_and_b32 v109, 0xffff0000, v121
    v_mov_b32 v30, v124
    v_lshlrev_b32 v106, 16, v125
    v_and_b32 v110, 0xffff0000, v125
    v_mov_b32 v31, v128
    v_lshlrev_b32 v107, 16, v129
    v_and_b32 v111, 0xffff0000, v129
    s_lshl_b32 s23, s44, 11
    s_add_u32 s23, s23, 0x1208000
    s_lshl_b32 s36, s46, 6
    s_add_u32 s36, s36, 0x900000
    s_add_u32 s37, s36, 0x104000
    s_add_u32 s38, s37, 0x104000
    s_add_u32 s39, s38, 0x104000
    s_waitcnt lgkmcnt(0)
    s_barrier
    ds_read_b64 v[12:13], v214 offset:0
    v_mfma_f32_16x16x32_bf16 v[64:67], v[28:31], a[136:139], 0
    ds_read_b64 v[16:17], v214 offset:1024
    v_mov_b32 v125, s56
    ds_read_b64 v[14:15], v214 offset:2048
    v_mfma_f32_16x16x32_bf16 v[68:71], v[28:31], a[140:143], 0
    ds_read_b64 v[18:19], v214 offset:3072
    v_mov_b32 v127, s56
    ds_read_b64 v[20:21], v215 offset:0
    v_mov_b32 v129, s56
    ds_read_b64 v[24:25], v215 offset:1024
    v_mov_b32 v131, s56
    ds_read_b64 v[22:23], v215 offset:2048
    ds_read_b64 v[26:27], v215 offset:3072
    ds_read2st64_b32 v[132:133], v9 offset0:0 offset1:77
    ds_read2st64_b32 v[134:135], v9 offset0:154 offset1:231
    ds_read2st64_b32 v[136:137], v10 offset0:4 offset1:81
    ds_read2st64_b32 v[138:139], v10 offset0:158 offset1:235
    s_waitcnt lgkmcnt(10)
    v_swap_b32 v13, v16
    ds_read2st64_b32 v[140:141], v9 offset0:8 offset1:85
    s_waitcnt lgkmcnt(9)
    v_swap_b32 v15, v18
    ds_read2st64_b32 v[142:143], v9 offset0:162 offset1:239
    s_waitcnt lgkmcnt(8)
    v_swap_b32 v21, v24
    v_mfma_f32_16x16x32_bf16 v[32:35], v[12:15], a[136:139], 0
    s_waitcnt lgkmcnt(6)
    v_swap_b32 v23, v26
    v_mfma_f32_16x16x32_bf16 v[36:39], v[12:15], a[140:143], 0
    ds_read2st64_b32 v[144:145], v10 offset0:12 offset1:89
    s_waitcnt lgkmcnt(6)
    v_bfi_b32 v132, s55, v199, v132
    v_mfma_f32_16x16x32_bf16 v[40:43], v[16:19], a[136:139], 0
    ds_read2st64_b32 v[146:147], v10 offset0:166 offset1:243
    v_bfi_b32 v133, s55, v200, v133
    v_mfma_f32_16x16x32_bf16 v[44:47], v[16:19], a[140:143], 0
    s_waitcnt lgkmcnt(6)
    v_bfi_b32 v134, s55, v201, v134
    v_bfi_b32 v135, s55, v202, v135
    v_mfma_f32_16x16x32_bf16 v[48:51], v[20:23], a[136:139], 0
    buffer_store_dwordx4 v[132:135], v211, s[4:7], s28 offen sc1
    v_mfma_f32_16x16x32_bf16 v[52:55], v[20:23], a[140:143], 0
    s_waitcnt lgkmcnt(5)
    v_bfi_b32 v136, s55, v199, v136
    v_bfi_b32 v137, s55, v200, v137
    v_mfma_f32_16x16x32_bf16 v[56:59], v[24:27], a[136:139], 0
    s_waitcnt lgkmcnt(4)
    v_bfi_b32 v138, s55, v201, v138
    v_bfi_b32 v139, s55, v202, v139
    v_mfma_f32_16x16x32_bf16 v[60:63], v[24:27], a[140:143], 0
    buffer_store_dwordx4 v[136:139], v211, s[4:7], s29 offen sc1
    s_waitcnt lgkmcnt(3)
    v_bfi_b32 v140, s55, v199, v140
    v_pk_mul_f32 v[72:73], v[32:33], v[220:221]
    v_pk_mul_f32 v[74:75], v[36:37], v[220:221]
    v_pk_mul_f32 v[76:77], v[34:35], v[222:223]
    v_pk_mul_f32 v[78:79], v[38:39], v[222:223]
    v_pk_mul_f32 v[80:81], v[40:41], v[220:221]
    v_pk_mul_f32 v[82:83], v[44:45], v[220:221]
    v_pk_mul_f32 v[84:85], v[42:43], v[222:223]
    v_pk_mul_f32 v[86:87], v[46:47], v[222:223]
    v_pk_fma_f32 v[72:73], v[36:37], v[224:225], v[72:73]
    v_pk_fma_f32 v[74:75], v[32:33], v[224:225], v[74:75] neg_lo:[1,0,0] neg_hi:[1,0,0]
    v_pk_fma_f32 v[76:77], v[38:39], v[226:227], v[76:77]
    v_pk_fma_f32 v[78:79], v[34:35], v[226:227], v[78:79] neg_lo:[1,0,0] neg_hi:[1,0,0]
    v_pk_fma_f32 v[80:81], v[44:45], v[224:225], v[80:81]
    v_pk_fma_f32 v[82:83], v[40:41], v[224:225], v[82:83] neg_lo:[1,0,0] neg_hi:[1,0,0]
    v_pk_fma_f32 v[84:85], v[46:47], v[226:227], v[84:85]
    v_pk_fma_f32 v[86:87], v[42:43], v[226:227], v[86:87] neg_lo:[1,0,0] neg_hi:[1,0,0]
    v_cvt_pk_bf16_f32 v12, v72, v74
    v_cvt_pk_bf16_f32 v13, v73, v75
    v_cvt_pk_bf16_f32 v14, v76, v78
    v_cvt_pk_bf16_f32 v15, v77, v79
    v_cvt_pk_bf16_f32 v16, v80, v82
    v_cvt_pk_bf16_f32 v17, v81, v83
    v_cvt_pk_bf16_f32 v18, v84, v86
    v_cvt_pk_bf16_f32 v19, v85, v87
    v_pk_mul_f32 v[88:89], v[48:49], v[220:221]
    v_pk_mul_f32 v[90:91], v[52:53], v[220:221]
    v_pk_mul_f32 v[92:93], v[50:51], v[222:223]
    v_pk_mul_f32 v[94:95], v[54:55], v[222:223]
    v_pk_mul_f32 v[96:97], v[56:57], v[220:221]
    v_pk_mul_f32 v[98:99], v[60:61], v[220:221]
    v_pk_mul_f32 v[100:101], v[58:59], v[222:223]
    v_pk_mul_f32 v[102:103], v[62:63], v[222:223]
    v_pk_fma_f32 v[88:89], v[52:53], v[224:225], v[88:89]
    v_pk_fma_f32 v[90:91], v[48:49], v[224:225], v[90:91] neg_lo:[1,0,0] neg_hi:[1,0,0]
    v_pk_fma_f32 v[92:93], v[54:55], v[226:227], v[92:93]
    v_pk_fma_f32 v[94:95], v[50:51], v[226:227], v[94:95] neg_lo:[1,0,0] neg_hi:[1,0,0]
    v_pk_fma_f32 v[96:97], v[60:61], v[224:225], v[96:97]
    v_pk_fma_f32 v[98:99], v[56:57], v[224:225], v[98:99] neg_lo:[1,0,0] neg_hi:[1,0,0]
    v_pk_fma_f32 v[100:101], v[62:63], v[226:227], v[100:101]
    v_pk_fma_f32 v[102:103], v[58:59], v[226:227], v[102:103] neg_lo:[1,0,0] neg_hi:[1,0,0]
    v_cvt_pk_bf16_f32 v20, v88, v90
    v_cvt_pk_bf16_f32 v21, v89, v91
    v_cvt_pk_bf16_f32 v22, v92, v94
    v_cvt_pk_bf16_f32 v23, v93, v95
    v_cvt_pk_bf16_f32 v24, v96, v98
    v_cvt_pk_bf16_f32 v25, v97, v99
    v_cvt_pk_bf16_f32 v26, v100, v102
    v_cvt_pk_bf16_f32 v27, v101, v103
    v_pk_mul_f32 v[72:73], v[64:65], v[220:221]
    v_pk_mul_f32 v[74:75], v[68:69], v[220:221]
    v_pk_fma_f32 v[72:73], v[68:69], v[224:225], v[72:73]
    v_pk_fma_f32 v[74:75], v[64:65], v[224:225], v[74:75] neg_lo:[1,0,0] neg_hi:[1,0,0]
    v_cvt_pk_bf16_f32 v28, v72, v74
    v_cvt_pk_bf16_f32 v29, v73, v75
    v_pk_mul_f32 v[76:77], v[66:67], v[222:223]
    v_pk_mul_f32 v[78:79], v[70:71], v[222:223]
    v_pk_fma_f32 v[76:77], v[70:71], v[226:227], v[76:77]
    v_pk_fma_f32 v[78:79], v[66:67], v[226:227], v[78:79] neg_lo:[1,0,0] neg_hi:[1,0,0]
    v_mfma_f32_16x16x32_bf16 v[32:35], v[248:251], v[12:15], 0
    v_cvt_pk_bf16_f32 v30, v76, v78
    v_cvt_pk_bf16_f32 v31, v77, v79
    v_mfma_f32_16x16x32_bf16 v[36:39], v[252:255], v[12:15], 0
    v_bfi_b32 v141, s55, v200, v141
    s_waitcnt lgkmcnt(2)
    v_bfi_b32 v142, s55, v201, v142
    v_mfma_f32_16x16x32_bf16 v[40:43], v[248:251], v[16:19], 0
    v_bfi_b32 v143, s55, v202, v143
    buffer_store_dwordx4 v[140:143], v211, s[4:7], s30 offen sc1
    v_pk_mul_f32 v[72:73], v[150:151], v[32:33]
    s_nop 0
    v_pk_mul_f32 v[74:75], v[150:151], v[36:37]
    v_pk_mul_f32 v[80:81], v[162:163], v[34:35]
    v_pk_mul_f32 v[82:83], v[162:163], v[38:39]
    s_nop 0
    v_pk_mul_f32 v[88:89], v[174:175], v[40:41]
    v_pk_mul_f32 v[96:97], v[186:187], v[42:43]
    v_pk_fma_f32 v[72:73], v[152:153], v[36:37], v[72:73] neg_lo:[1,0,0] neg_hi:[1,0,0]
    v_pk_fma_f32 v[74:75], v[152:153], v[32:33], v[74:75]
    v_pk_fma_f32 v[80:81], v[164:165], v[38:39], v[80:81] neg_lo:[1,0,0] neg_hi:[1,0,0]
    v_pk_fma_f32 v[82:83], v[164:165], v[34:35], v[82:83]
    v_mfma_f32_16x16x32_bf16 v[44:47], v[252:255], v[16:19], 0
    s_waitcnt lgkmcnt(1)
    v_bfi_b32 v144, s55, v199, v144
    v_bfi_b32 v145, s55, v200, v145
    v_mfma_f32_16x16x32_bf16 v[48:51], v[248:251], v[20:23], 0
    s_waitcnt lgkmcnt(0)
    v_bfi_b32 v146, s55, v201, v146
    v_bfi_b32 v147, s55, v202, v147
    v_mfma_f32_16x16x32_bf16 v[52:55], v[252:255], v[20:23], 0
    buffer_store_dwordx4 v[144:147], v211, s[4:7], s31 offen sc1
    v_mfma_f32_16x16x32_bf16 v[56:59], v[248:251], v[24:27], 0
    v_mfma_f32_16x16x32_bf16 v[60:63], v[252:255], v[24:27], 0
    v_mfma_f32_16x16x32_bf16 v[64:67], v[248:251], v[28:31], 0
    v_mfma_f32_16x16x32_bf16 v[68:71], v[252:255], v[28:31], 0
    v_pk_mul_f32 v[90:91], v[174:175], v[44:45]
    v_pk_mul_f32 v[98:99], v[186:187], v[46:47]
    v_pk_fma_f32 v[88:89], v[176:177], v[44:45], v[88:89] neg_lo:[1,0,0] neg_hi:[1,0,0]
    v_pk_fma_f32 v[90:91], v[176:177], v[40:41], v[90:91]
    v_pk_fma_f32 v[96:97], v[188:189], v[46:47], v[96:97] neg_lo:[1,0,0] neg_hi:[1,0,0]
    v_pk_fma_f32 v[98:99], v[188:189], v[42:43], v[98:99]
    v_pk_fma_f32 v[72:73], v[158:159], v[48:49], v[72:73]
    v_pk_fma_f32 v[74:75], v[158:159], v[52:53], v[74:75]
    v_pk_fma_f32 v[80:81], v[170:171], v[50:51], v[80:81]
    v_pk_fma_f32 v[82:83], v[170:171], v[54:55], v[82:83]
    v_pk_fma_f32 v[88:89], v[182:183], v[56:57], v[88:89]
    v_pk_fma_f32 v[90:91], v[182:183], v[60:61], v[90:91]
    v_pk_fma_f32 v[96:97], v[194:195], v[58:59], v[96:97]
    v_pk_fma_f32 v[98:99], v[194:195], v[62:63], v[98:99]
    v_pk_fma_f32 v[72:73], v[160:161], v[52:53], v[72:73] neg_lo:[1,0,0] neg_hi:[1,0,0]
    v_pk_fma_f32 v[74:75], v[160:161], v[48:49], v[74:75]
    v_pk_fma_f32 v[80:81], v[172:173], v[54:55], v[80:81] neg_lo:[1,0,0] neg_hi:[1,0,0]
    v_pk_fma_f32 v[82:83], v[172:173], v[50:51], v[82:83]
    v_pk_fma_f32 v[88:89], v[184:185], v[60:61], v[88:89] neg_lo:[1,0,0] neg_hi:[1,0,0]
    v_pk_fma_f32 v[90:91], v[184:185], v[56:57], v[90:91]
    v_pk_fma_f32 v[96:97], v[196:197], v[62:63], v[96:97] neg_lo:[1,0,0] neg_hi:[1,0,0]
    v_pk_fma_f32 v[98:99], v[196:197], v[58:59], v[98:99]
    v_pk_mul_f32 v[76:77], v[154:155], v[48:49]
    v_pk_mul_f32 v[78:79], v[154:155], v[52:53]
    v_pk_mul_f32 v[84:85], v[166:167], v[50:51]
    v_pk_mul_f32 v[86:87], v[166:167], v[54:55]
    v_pk_mul_f32 v[92:93], v[178:179], v[56:57]
    v_pk_mul_f32 v[94:95], v[178:179], v[60:61]
    v_pk_mul_f32 v[100:101], v[190:191], v[58:59]
    v_pk_mul_f32 v[102:103], v[190:191], v[62:63]
    v_cvt_pk_bf16_f32 v12, v72, -v74
    v_cvt_pk_bf16_f32 v13, v73, -v75
    v_cvt_pk_bf16_f32 v14, v80, -v82
    v_cvt_pk_bf16_f32 v15, v81, -v83
    v_cvt_pk_bf16_f32 v16, v88, -v90
    v_cvt_pk_bf16_f32 v17, v89, -v91
    v_cvt_pk_bf16_f32 v18, v96, -v98
    v_cvt_pk_bf16_f32 v19, v97, -v99
    v_pk_fma_f32 v[76:77], v[156:157], v[52:53], v[76:77] neg_lo:[1,0,0] neg_hi:[1,0,0]
    v_pk_fma_f32 v[78:79], v[156:157], v[48:49], v[78:79]
    v_pk_fma_f32 v[84:85], v[168:169], v[54:55], v[84:85] neg_lo:[1,0,0] neg_hi:[1,0,0]
    v_pk_fma_f32 v[86:87], v[168:169], v[50:51], v[86:87]
    v_pk_fma_f32 v[92:93], v[180:181], v[60:61], v[92:93] neg_lo:[1,0,0] neg_hi:[1,0,0]
    v_pk_fma_f32 v[94:95], v[180:181], v[56:57], v[94:95]
    v_pk_fma_f32 v[100:101], v[192:193], v[62:63], v[100:101] neg_lo:[1,0,0] neg_hi:[1,0,0]
    v_pk_fma_f32 v[102:103], v[192:193], v[58:59], v[102:103]
    v_pk_fma_f32 v[76:77], v[158:159], v[32:33], v[76:77] neg_lo:[1,0,0] neg_hi:[1,0,0]
    v_pk_fma_f32 v[78:79], v[158:159], v[36:37], v[78:79] neg_lo:[1,0,0] neg_hi:[1,0,0]
    v_pk_fma_f32 v[84:85], v[170:171], v[34:35], v[84:85] neg_lo:[1,0,0] neg_hi:[1,0,0]
    v_pk_fma_f32 v[86:87], v[170:171], v[38:39], v[86:87] neg_lo:[1,0,0] neg_hi:[1,0,0]
    v_pk_fma_f32 v[92:93], v[182:183], v[40:41], v[92:93] neg_lo:[1,0,0] neg_hi:[1,0,0]
    v_pk_fma_f32 v[94:95], v[182:183], v[44:45], v[94:95] neg_lo:[1,0,0] neg_hi:[1,0,0]
    v_pk_fma_f32 v[100:101], v[194:195], v[42:43], v[100:101] neg_lo:[1,0,0] neg_hi:[1,0,0]
    v_pk_fma_f32 v[102:103], v[194:195], v[46:47], v[102:103] neg_lo:[1,0,0] neg_hi:[1,0,0]
    v_pk_fma_f32 v[76:77], v[160:161], v[36:37], v[76:77]
    v_pk_fma_f32 v[78:79], v[160:161], v[32:33], v[78:79] neg_lo:[1,0,0] neg_hi:[1,0,0]
    v_pk_fma_f32 v[84:85], v[172:173], v[38:39], v[84:85]
    v_pk_fma_f32 v[86:87], v[172:173], v[34:35], v[86:87] neg_lo:[1,0,0] neg_hi:[1,0,0]
    v_pk_fma_f32 v[92:93], v[184:185], v[44:45], v[92:93]
    v_pk_fma_f32 v[94:95], v[184:185], v[40:41], v[94:95] neg_lo:[1,0,0] neg_hi:[1,0,0]
    v_pk_fma_f32 v[100:101], v[196:197], v[46:47], v[100:101]
    v_pk_fma_f32 v[102:103], v[196:197], v[42:43], v[102:103] neg_lo:[1,0,0] neg_hi:[1,0,0]
    v_cvt_pk_bf16_f32 v20, v76, -v78
    v_cvt_pk_bf16_f32 v21, v77, -v79
    v_cvt_pk_bf16_f32 v22, v84, -v86
    v_cvt_pk_bf16_f32 v23, v85, -v87
    v_cvt_pk_bf16_f32 v24, v92, -v94
    v_cvt_pk_bf16_f32 v25, v93, -v95
    v_cvt_pk_bf16_f32 v26, v100, -v102
    v_cvt_pk_bf16_f32 v27, v101, -v103
    v_pk_mul_f32 v[116:117], v[104:105], v[64:65]
    v_pk_mul_f32 v[118:119], v[104:105], v[68:69]
    v_pk_mul_f32 v[120:121], v[106:107], v[66:67]
    v_pk_mul_f32 v[122:123], v[106:107], v[70:71]
    v_pk_fma_f32 v[116:117], v[108:109], v[68:69], v[116:117] neg_lo:[1,0,0] neg_hi:[1,0,0]
    v_pk_fma_f32 v[118:119], v[108:109], v[64:65], v[118:119]
    v_pk_fma_f32 v[120:121], v[110:111], v[70:71], v[120:121] neg_lo:[1,0,0] neg_hi:[1,0,0]
    v_pk_fma_f32 v[122:123], v[110:111], v[66:67], v[122:123]
    v_mfma_f32_16x16x32_bf16 v[32:35], v[12:15], v[248:251], 0
    v_cvt_pk_bf16_f32 v28, v116, -v118
    v_cvt_pk_bf16_f32 v29, v117, -v119
    v_mfma_f32_16x16x32_bf16 v[36:39], v[12:15], v[252:255], 0
    v_cvt_pk_bf16_f32 v30, v120, -v122
    v_cvt_pk_bf16_f32 v31, v121, -v123
    v_mfma_f32_16x16x32_bf16 v[40:43], v[16:19], v[248:251], 0
    v_mfma_f32_16x16x32_bf16 v[44:47], v[16:19], v[252:255], 0
    v_mfma_f32_16x16x32_bf16 v[48:51], v[20:23], v[248:251], 0
    v_mfma_f32_16x16x32_bf16 v[52:55], v[20:23], v[252:255], 0
    v_mfma_f32_16x16x32_bf16 v[56:59], v[24:27], v[248:251], 0
    v_mfma_f32_16x16x32_bf16 v[60:63], v[24:27], v[252:255], 0
    v_mfma_f32_16x16x32_bf16 v[64:67], v[28:31], v[248:251], 0
    v_mfma_f32_16x16x32_bf16 v[68:71], v[28:31], v[252:255], 0
    v_pk_mul_f32 v[72:73], v[32:33], v[228:229]
    v_pk_mul_f32 v[74:75], v[36:37], v[228:229]
    v_pk_mul_f32 v[76:77], v[34:35], v[230:231]
    v_pk_mul_f32 v[78:79], v[38:39], v[230:231]
    v_pk_mul_f32 v[80:81], v[40:41], v[228:229]
    v_pk_mul_f32 v[82:83], v[44:45], v[228:229]
    v_pk_mul_f32 v[84:85], v[42:43], v[230:231]
    v_pk_mul_f32 v[86:87], v[46:47], v[230:231]
    v_pk_fma_f32 v[72:73], v[36:37], v[232:233], v[72:73]
    v_pk_fma_f32 v[74:75], v[32:33], v[232:233], v[74:75] neg_lo:[1,0,0] neg_hi:[1,0,0]
    v_pk_fma_f32 v[76:77], v[38:39], v[234:235], v[76:77]
    v_pk_fma_f32 v[78:79], v[34:35], v[234:235], v[78:79] neg_lo:[1,0,0] neg_hi:[1,0,0]
    v_pk_fma_f32 v[80:81], v[44:45], v[232:233], v[80:81]
    v_pk_fma_f32 v[82:83], v[40:41], v[232:233], v[82:83] neg_lo:[1,0,0] neg_hi:[1,0,0]
    v_pk_fma_f32 v[84:85], v[46:47], v[234:235], v[84:85]
    v_pk_fma_f32 v[86:87], v[42:43], v[234:235], v[86:87] neg_lo:[1,0,0] neg_hi:[1,0,0]
    v_cvt_pk_bf16_f32 v12, v72, v74
    v_cvt_pk_bf16_f32 v13, v73, v75
    v_cvt_pk_bf16_f32 v14, v76, v78
    v_cvt_pk_bf16_f32 v15, v77, v79
    v_cvt_pk_bf16_f32 v16, v80, v82
    v_cvt_pk_bf16_f32 v17, v81, v83
    v_cvt_pk_bf16_f32 v18, v84, v86
    v_cvt_pk_bf16_f32 v19, v85, v87
    v_pk_mul_f32 v[88:89], v[48:49], v[228:229]
    v_pk_mul_f32 v[90:91], v[52:53], v[228:229]
    v_pk_mul_f32 v[92:93], v[50:51], v[230:231]
    v_pk_mul_f32 v[94:95], v[54:55], v[230:231]
    v_pk_mul_f32 v[96:97], v[56:57], v[228:229]
    v_pk_mul_f32 v[98:99], v[60:61], v[228:229]
    v_pk_mul_f32 v[100:101], v[58:59], v[230:231]
    v_pk_mul_f32 v[102:103], v[62:63], v[230:231]
    v_pk_fma_f32 v[88:89], v[52:53], v[232:233], v[88:89]
    v_pk_fma_f32 v[90:91], v[48:49], v[232:233], v[90:91] neg_lo:[1,0,0] neg_hi:[1,0,0]
    v_pk_fma_f32 v[92:93], v[54:55], v[234:235], v[92:93]
    v_pk_fma_f32 v[94:95], v[50:51], v[234:235], v[94:95] neg_lo:[1,0,0] neg_hi:[1,0,0]
    v_pk_fma_f32 v[96:97], v[60:61], v[232:233], v[96:97]
    v_pk_fma_f32 v[98:99], v[56:57], v[232:233], v[98:99] neg_lo:[1,0,0] neg_hi:[1,0,0]
    v_pk_fma_f32 v[100:101], v[62:63], v[234:235], v[100:101]
    v_pk_fma_f32 v[102:103], v[58:59], v[234:235], v[102:103] neg_lo:[1,0,0] neg_hi:[1,0,0]
    v_cvt_pk_bf16_f32 v20, v88, v90
    v_cvt_pk_bf16_f32 v21, v89, v91
    v_cvt_pk_bf16_f32 v22, v92, v94
    v_cvt_pk_bf16_f32 v23, v93, v95
    v_cvt_pk_bf16_f32 v24, v96, v98
    v_cvt_pk_bf16_f32 v25, v97, v99
    v_cvt_pk_bf16_f32 v26, v100, v102
    v_cvt_pk_bf16_f32 v27, v101, v103
    v_pk_mul_f32 v[72:73], v[64:65], v[228:229]
    v_pk_mul_f32 v[74:75], v[68:69], v[228:229]
    v_pk_mul_f32 v[76:77], v[66:67], v[230:231]
    v_pk_mul_f32 v[78:79], v[70:71], v[230:231]
    v_pk_fma_f32 v[72:73], v[68:69], v[232:233], v[72:73]
    v_pk_fma_f32 v[74:75], v[64:65], v[232:233], v[74:75] neg_lo:[1,0,0] neg_hi:[1,0,0]
    v_pk_fma_f32 v[76:77], v[70:71], v[234:235], v[76:77]
    v_pk_fma_f32 v[78:79], v[66:67], v[234:235], v[78:79] neg_lo:[1,0,0] neg_hi:[1,0,0]
    v_mfma_f32_16x16x32_bf16 v[32:35], a[144:147], v[12:15], 0
    v_cvt_pk_bf16_f32 v28, v72, v74
    v_cvt_pk_bf16_f32 v29, v73, v75
    v_mfma_f32_16x16x32_bf16 v[36:39], a[148:151], v[12:15], 0
    v_cvt_pk_bf16_f32 v30, v76, v78
    v_cvt_pk_bf16_f32 v31, v77, v79
    v_mfma_f32_16x16x32_bf16 v[40:43], a[144:147], v[16:19], 0
    v_mfma_f32_16x16x32_bf16 v[44:47], a[148:151], v[16:19], 0
    s_nop 3
    v_cvt_pk_bf16_f32 v12, v32, v36
    v_cvt_pk_bf16_f32 v14, v33, v37
    v_mfma_f32_16x16x32_bf16 v[48:51], a[144:147], v[20:23], 0
    v_cvt_pk_bf16_f32 v16, v34, v38
    v_cvt_pk_bf16_f32 v18, v35, v39
    v_mfma_f32_16x16x32_bf16 v[52:55], a[148:151], v[20:23], 0
    v_cvt_pk_bf16_f32 v13, v40, v44
    ds_write_b64 v212, v[12:13] offset:16384
    v_cvt_pk_bf16_f32 v15, v41, v45
    ds_write_b64 v212, v[14:15] offset:17408
    v_mfma_f32_16x16x32_bf16 v[56:59], a[144:147], v[24:27], 0
    v_cvt_pk_bf16_f32 v17, v42, v46
    ds_write_b64 v212, v[16:17] offset:18432
    v_mfma_f32_16x16x32_bf16 v[60:63], a[148:151], v[24:27], 0
    v_cvt_pk_bf16_f32 v19, v43, v47
    ds_write_b64 v212, v[18:19] offset:19456
    v_mfma_f32_16x16x32_bf16 v[64:67], a[144:147], v[28:31], 0
    v_cvt_pk_bf16_f32 v20, v48, v52
    s_nop 3
    v_cvt_pk_bf16_f32 v21, v56, v60
    v_mfma_f32_16x16x32_bf16 v[68:71], a[148:151], v[28:31], 0
    ds_write_b64 v213, v[20:21] offset:16384
    v_cvt_pk_bf16_f32 v22, v49, v53
    v_cvt_pk_bf16_f32 v23, v57, v61
    ds_write_b64 v213, v[22:23] offset:17408
    s_nop 3
    v_cvt_pk_bf16_f32 v124, v64, v68
    buffer_store_dwordx2 v[124:125], v205, s[4:7], s23 offen sc1
    v_cvt_pk_bf16_f32 v126, v65, v69
    v_cvt_pk_bf16_f32 v24, v50, v54
    v_cvt_pk_bf16_f32 v25, v58, v62
    ds_write_b64 v213, v[24:25] offset:18432
    buffer_store_dwordx2 v[126:127], v205, s[4:7], s23 offen offset:128 sc1
    v_cvt_pk_bf16_f32 v128, v66, v70
    v_cvt_pk_bf16_f32 v26, v51, v55
    v_cvt_pk_bf16_f32 v27, v59, v63
    v_cvt_pk_bf16_f32 v130, v67, v71
    ds_write_b64 v213, v[26:27] offset:19456
    buffer_store_dwordx2 v[128:129], v205, s[4:7], s23 offen offset:256 sc1
    buffer_store_dwordx2 v[130:131], v205, s[4:7], s23 offen offset:384 sc1
    s_waitcnt lgkmcnt(0)
    s_barrier
    ds_read_b128 v[32:35], v240 offset:16384
    ds_read_b128 v[36:39], v240 offset:20480
    ds_read_b128 v[40:43], v240 offset:24576
    ds_read_b128 v[44:47], v240 offset:28672
    s_waitcnt lgkmcnt(3)
    v_bfi_b32 v32, s55, v199, v32
    v_bfi_b32 v33, s55, v200, v33
    v_bfi_b32 v34, s55, v201, v34
    v_bfi_b32 v35, s55, v202, v35
    buffer_store_dwordx4 v[32:35], v211, s[4:7], s36 offen sc1
    s_waitcnt lgkmcnt(2)
    v_bfi_b32 v36, s55, v199, v36
    v_bfi_b32 v37, s55, v200, v37
    v_bfi_b32 v38, s55, v201, v38
    v_bfi_b32 v39, s55, v202, v39
    buffer_store_dwordx4 v[36:39], v211, s[4:7], s37 offen sc1
    s_waitcnt lgkmcnt(1)
    v_bfi_b32 v40, s55, v199, v40
    v_bfi_b32 v41, s55, v200, v41
    v_bfi_b32 v42, s55, v201, v42
    v_bfi_b32 v43, s55, v202, v43
    buffer_store_dwordx4 v[40:43], v211, s[4:7], s38 offen sc1
    s_waitcnt lgkmcnt(0)
    v_bfi_b32 v44, s55, v199, v44
    v_bfi_b32 v45, s55, v200, v45
    v_bfi_b32 v46, s55, v201, v46
    v_bfi_b32 v47, s55, v202, v47
    buffer_store_dwordx4 v[44:47], v211, s[4:7], s39 offen sc1
k_p2done:
    s_barrier
    s_mul_i32 s22, s46, 0x4100
    s_add_u32 s26, s35, s22
    s_add_u32 s26, s26, 0xd80000
    v_and_b32 v4, 1, v2
    v_lshlrev_b32 v198, 13, v4
    v_lshrrev_b32 v9, 1, v2
    v_lshl_add_u32 v4, v9, 5, v198
    v_lshrrev_b32 v5, 1, v1
    v_lshl_add_u32 v4, v5, 6, v4
    v_and_b32 v6, 1, v1
    v_lshl_add_u32 v196, v6, 4, v4
    v_lshlrev_b32 v6, 3, v6
    v_lshrrev_b32 v7, 2, v1
    v_and_b32 v8, 1, v1
    v_lshl_add_u32 v6, v9, 4, v6
    v_lshl_add_u32 v7, v7, 1, v8
    v_lshrrev_b32 v6, v6, s54
    v_and_b32 v8, 1, v2
    v_bfe_u32 v244, v6, 0, 2
    v_bfe_u32 v245, v6, 2, 2
    v_bfe_u32 v246, v6, 4, 2
    v_bfe_u32 v247, v6, 6, 2
    v_cvt_f32_u32 v7, v7
    v_cvt_f32_u32 v8, v8
    v_bfe_u32 v10, v1, 1, 1
    v_lshlrev_b32 v6, 6, v1
    v_lshrrev_b32 v197, 2, v1
    v_mul_f32 v7, 0x3e000000, v7
    v_mul_f32 v8, 4.0, v8
    v_cmp_eq_u32 vcc, v10, v9
    v_lshl_add_u32 v6, v2, 12, v6
    v_xor_b32 v197, s3, v197
    v_mul_f32 v8, v8, v7
    v_lshl_add_u32 v197, v197, 4, v6
    v_add_f32 v156, v8, v7
    v_cos_f32 v153, v8
    v_sin_f32 v154, v8
    v_cvt_f32_u32 v5, v1
    v_cvt_f32_u32 v6, v2
    v_add_f32 v160, v156, v7
    v_add_f32 v164, v160, v7
    v_mul_f32 v8, v5, v6
    v_mul_f32 v8, 0x3d800000, v8
    v_mul_f32 v7, 0x3e800000, v5
    v_lshlrev_b32 v10, 31, v10
    v_cndmask_b32 v212, 0, 1.0, vcc
    v_add_f32 v172, v8, v7
    v_xor_b32 v213, v212, v10
    v_add_f32 v176, v172, v7
    v_cos_f32 v169, v8
    v_sin_f32 v170, v8
    v_add_f32 v180, v176, v7
    v_mul_f32 v10, 0x3d000000, v6
    v_cos_f32 v157, v156
    v_sin_f32 v158, v156
    v_add_f32 v8, v8, v10
    v_add_f32 v7, 0x3e000000, v7
    v_mul_f32 v155, v212, v153
    v_mul_f32 v52, v212, v154
    v_cos_f32 v161, v160
    v_sin_f32 v162, v160
    v_add_f32 v156, v8, v7
    v_cvt_pk_bf16_f32 v52, v155, v52
    v_cos_f32 v165, v164
    v_sin_f32 v166, v164
    v_add_f32 v160, v156, v7
    v_mul_f32 v155, v213, v154
    v_mul_f32 v56, v213, v153
    v_add_f32 v164, v160, v7
    v_cos_f32 v153, v8
    v_sin_f32 v154, v8
    v_mul_f32 v7, 0x3b800000, v5
    v_mul_f32 v8, v7, v6
    v_mul_f32 v8, 4.0, v8
    v_cos_f32 v84, v8
    v_sin_f32 v100, v8
    v_add_f32 v8, v8, v7
    v_cos_f32 v85, v8
    v_sin_f32 v101, v8
    v_add_f32 v8, v8, v7
    v_cos_f32 v86, v8
    v_sin_f32 v102, v8
    v_add_f32 v8, v8, v7
    v_mul_f32 v7, 0x3b800000, v5
    v_cos_f32 v87, v8
    v_sin_f32 v103, v8
    v_add_f32 v7, 0x3b000000, v7
    v_mul_f32 v8, v7, v6
    v_mul_f32 v8, 4.0, v8
    v_cos_f32 v88, v8
    v_sin_f32 v104, v8
    v_add_f32 v8, v8, v7
    v_cos_f32 v89, v8
    v_sin_f32 v105, v8
    v_add_f32 v8, v8, v7
    v_cos_f32 v90, v8
    v_sin_f32 v106, v8
    s_mov_b32 s8, s42
    s_mov_b32 s9, s43
    s_lshl_b32 s23, s3, 9
    s_add_u32 s23, s23, s22
    v_add_f32 v8, v8, v7
    s_add_u32 s23, s23, 0x900000
    s_add_u32 s24, s23, 0x1000
    v_cos_f32 v91, v8
    v_sin_f32 v107, v8
    s_lshl_b32 s25, s46, 3
    s_add_u32 s25, s25, 0x1208000
    s_add_u32 s27, s25, 0x1000
    s_lshl_b32 s58, s3, 4
    v_and_b32 v7, 1, v2
    v_add_u32 v8, s58, v1
    v_lshlrev_b32 v7, 3, v7
    v_bfe_u32 v10, v8, 2, 1
    v_lshl_add_u32 v7, v9, 4, v7
    v_lshlrev_b32 v10, 4, v10
    v_xor_b32 v10, v10, v7
    v_lshl_add_u32 v184, v8, 5, v10
    v_sub_u32 v9, 0x7f, v8
    v_bfe_u32 v10, v9, 2, 1
    v_lshlrev_b32 v10, 4, v10
    v_xor_b32 v10, v10, v7
    v_lshl_add_u32 v186, v9, 5, v10
    v_add_u32 v9, 1, v9
    v_and_b32 v9, 0x7f, v9
    v_bfe_u32 v10, v9, 2, 1
    v_lshlrev_b32 v10, 4, v10
    v_xor_b32 v10, v10, v7
    v_lshl_add_u32 v188, v9, 5, v10
    v_mul_f32 v159, v212, v157
    v_mul_f32 v53, v212, v158
    v_mul_f32 v163, v212, v161
    v_mul_f32 v54, v212, v162
    v_mul_f32 v167, v212, v165
    v_mul_f32 v55, v212, v166
    v_and_b32 v9, 3, v1
    v_cvt_pk_bf16_f32 v53, v159, v53
    v_cvt_pk_bf16_f32 v54, v163, v54
    v_cvt_pk_bf16_f32 v55, v167, v55
    v_lshlrev_b32 v9, 12, v9
    v_lshrrev_b32 v10, 2, v1
    v_cmp_eq_u32 vcc, 0, v8
    v_mul_f32 v159, v213, v158
    v_mul_f32 v57, v213, v157
    v_mul_f32 v163, v213, v162
    v_mul_f32 v58, v213, v161
    v_mul_f32 v167, v213, v166
    v_mul_f32 v59, v213, v165
    v_lshl_add_u32 v9, v10, 5, v9
    v_cos_f32 v157, v156
    v_sin_f32 v158, v156
    v_cos_f32 v161, v160
    v_sin_f32 v162, v160
    v_cos_f32 v165, v164
    v_sin_f32 v166, v164
    v_xor_b32 v10, v1, v2
    v_cos_f32 v173, v172
    v_sin_f32 v174, v172
    v_cos_f32 v177, v176
    v_sin_f32 v178, v176
    v_cos_f32 v181, v180
    v_sin_f32 v182, v180
    v_xor_b32 v10, s20, v10
    v_lshl_add_u32 v9, v2, 7, v9
    v_and_b32 v10, 1, v10
    v_mul_u32_u24 v244, 0x8001, v244
    v_mul_u32_u24 v245, 0x8001, v245
    v_mul_u32_u24 v246, 0x8001, v246
    v_mul_u32_u24 v247, 0x8001, v247
    v_cvt_pk_bf16_f32 v68, v153, v154
    v_cvt_pk_bf16_f32 v72, -v154, v153
    v_cvt_pk_bf16_f32 v69, v157, v158
    v_cvt_pk_bf16_f32 v73, -v158, v157
    v_cvt_pk_bf16_f32 v70, v161, v162
    v_cvt_pk_bf16_f32 v74, -v162, v161
    v_cvt_pk_bf16_f32 v71, v165, v166
    v_cvt_pk_bf16_f32 v75, -v166, v165
    v_lshl_add_u32 v9, v10, 4, v9
    v_lshlrev_b32 v203, 3, v1
    v_and_b32 v244, s55, v244
    v_and_b32 v245, s55, v245
    v_and_b32 v246, s55, v246
    v_and_b32 v247, s55, v247
    v_cvt_pk_bf16_f32 v56, -v155, v56
    v_cvt_pk_bf16_f32 v57, -v159, v57
    v_cvt_pk_bf16_f32 v58, -v163, v58
    v_cvt_pk_bf16_f32 v59, -v167, v59
    v_cvt_pk_bf16_f32 v60, v169, v170
    v_cvt_pk_bf16_f32 v64, -v170, v169
    v_cvt_pk_bf16_f32 v61, v173, v174
    v_cvt_pk_bf16_f32 v65, -v174, v173
    v_cvt_pk_bf16_f32 v62, v177, v178
    v_cvt_pk_bf16_f32 v66, -v178, v177
    v_cvt_pk_bf16_f32 v63, v181, v182
    v_cvt_pk_bf16_f32 v67, -v182, v181
    v_xor_b32 v76, 0x80008000, v68
    v_xor_b32 v77, 0x80008000, v69
    v_xor_b32 v78, 0x80008000, v70
    v_xor_b32 v79, 0x80008000, v71
    v_xor_b32 v80, 0x80008000, v72
    v_xor_b32 v81, 0x80008000, v73
    v_xor_b32 v82, 0x80008000, v74
    v_xor_b32 v83, 0x80008000, v75
    v_xor_b32 v185, 16, v184
    v_xor_b32 v187, 16, v186
    v_xor_b32 v189, 16, v188
    v_add_u32 v190, s21, v9
    v_lshlrev_b32 v191, 3, v2
    v_cndmask_b32 v194, 0, 0.5, vcc
    v_xor_b32 v148, 0x80008000, v252
    v_xor_b32 v149, 0x80008000, v253
    v_xor_b32 v150, 0x80008000, v254
    v_xor_b32 v151, 0x80008000, v255
    v_lshl_add_u32 v203, v2, 9, v203
    s_lshl_b32 s30, s47, 11
    s_add_u32 s31, s30, 0x80000
    s_mov_b32 s57, 0x20000
tl_10:
    buffer_load_dwordx4 v[28:31], v208, s[4:7], s26 offen sc1
    buffer_load_dwordx4 v[32:35], v208, s[4:7], s26 offen offset:1024 sc1
    buffer_load_dwordx4 v[36:39], v208, s[4:7], s26 offen offset:2048 sc1
    buffer_load_dwordx4 v[40:43], v208, s[4:7], s26 offen offset:3072 sc1
    s_waitcnt vmcnt(0)
tc_11:
    v_xor_b32 v4, v28, v199
    v_xor_b32 v5, v29, v200
    v_xor_b32 v6, v30, v201
    v_xor_b32 v7, v31, v202
    v_bitop3_b32 v4, v4, v32, v199 bitop3:0xf6
    v_bitop3_b32 v5, v5, v33, v200 bitop3:0xf6
    v_bitop3_b32 v6, v6, v34, v201 bitop3:0xf6
    v_bitop3_b32 v7, v7, v35, v202 bitop3:0xf6
    v_bitop3_b32 v4, v4, v36, v199 bitop3:0xf6
    v_bitop3_b32 v5, v5, v37, v200 bitop3:0xf6
    v_bitop3_b32 v6, v6, v38, v201 bitop3:0xf6
    v_bitop3_b32 v7, v7, v39, v202 bitop3:0xf6
    v_bitop3_b32 v4, v4, v40, v199 bitop3:0xf6
    v_bitop3_b32 v5, v5, v41, v200 bitop3:0xf6
    v_bitop3_b32 v6, v6, v42, v201 bitop3:0xf6
    v_bitop3_b32 v7, v7, v43, v202 bitop3:0xf6
    v_or3_b32 v4, v4, v5, v6
    v_or_b32 v4, v4, v7
    v_and_b32 v4, s55, v4
    s_nop 1
    v_or_b32_dpp v4, v4, v4 quad_perm:[1,0,3,2] row_mask:0xf bank_mask:0xf
    s_nop 1
    v_or_b32_dpp v4, v4, v4 quad_perm:[2,3,0,1] row_mask:0xf bank_mask:0xf
    v_cmp_ne_u32 vcc, 0, v4
    s_nop 0
    s_and_b64 exec, exec, vcc
    s_cbranch_scc0 td_12
    s_sub_u32 s57, s57, 1
    s_cbranch_scc0 tl_10
td_12:
    s_mov_b64 exec, -1
    ds_write_b128 v206, v[28:31] offset:16384
    ds_write_b128 v206, v[32:35] offset:17408
    ds_write_b128 v206, v[36:39] offset:18432
    ds_write_b128 v206, v[40:43] offset:19456
    s_waitcnt lgkmcnt(0)
    s_barrier
    s_cmp_eq_u32 s3, 3
    s_cbranch_scc1 k_z2x
    buffer_load_dwordx4 v[12:15], v196, s[4:7], s23 offen sc1
    buffer_load_dwordx4 v[16:19], v196, s[4:7], s23 offen offset:2048 sc1
    buffer_load_dwordx4 v[20:23], v196, s[4:7], s24 offen sc1
    buffer_load_dwordx4 v[24:27], v196, s[4:7], s24 offen offset:2048 sc1
    v_accvgpr_read_b32 v233, a168
    v_accvgpr_read_b32 v235, a152
    v_lshlrev_b32 v232, 16, v233
    v_lshlrev_b32 v234, 16, v235
    v_and_b32 v233, 0xffff0000, v233
    v_and_b32 v235, 0xffff0000, v235
    v_pk_mul_f32 v[232:233], v[232:233], v[234:235]
    v_cvt_pk_bf16_f32 v212, v232, v233
    v_accvgpr_read_b32 v237, a172
    v_accvgpr_read_b32 v239, a153
    v_accvgpr_read_b32 v241, a176
    v_accvgpr_read_b32 v243, a154
    v_accvgpr_read_b32 v233, a180
    v_accvgpr_read_b32 v235, a155
    v_lshlrev_b32 v236, 16, v237
    v_lshlrev_b32 v238, 16, v239
    v_lshlrev_b32 v240, 16, v241
    v_lshlrev_b32 v242, 16, v243
    v_lshlrev_b32 v232, 16, v233
    v_lshlrev_b32 v234, 16, v235
    v_and_b32 v237, 0xffff0000, v237
    v_and_b32 v239, 0xffff0000, v239
    v_and_b32 v241, 0xffff0000, v241
    v_and_b32 v243, 0xffff0000, v243
    v_and_b32 v233, 0xffff0000, v233
    v_and_b32 v235, 0xffff0000, v235
    v_pk_mul_f32 v[236:237], v[236:237], v[238:239]
    v_pk_mul_f32 v[240:241], v[240:241], v[242:243]
    v_pk_mul_f32 v[232:233], v[232:233], v[234:235]
    v_cvt_pk_bf16_f32 v213, v236, v237
    v_cvt_pk_bf16_f32 v214, v240, v241
    v_cvt_pk_bf16_f32 v215, v232, v233
    v_accvgpr_read_b32 v237, a169
    v_accvgpr_read_b32 v239, a156
    v_accvgpr_read_b32 v241, a173
    v_accvgpr_read_b32 v243, a157
    v_accvgpr_read_b32 v233, a177
    v_accvgpr_read_b32 v235, a158
    v_lshlrev_b32 v236, 16, v237
    v_lshlrev_b32 v238, 16, v239
    v_lshlrev_b32 v240, 16, v241
    v_lshlrev_b32 v242, 16, v243
    v_lshlrev_b32 v232, 16, v233
    v_lshlrev_b32 v234, 16, v235
    v_and_b32 v237, 0xffff0000, v237
    v_and_b32 v239, 0xffff0000, v239
    v_and_b32 v241, 0xffff0000, v241
    v_and_b32 v243, 0xffff0000, v243
    v_and_b32 v233, 0xffff0000, v233
    v_and_b32 v235, 0xffff0000, v235
    v_pk_mul_f32 v[236:237], v[236:237], v[238:239]
    v_pk_mul_f32 v[240:241], v[240:241], v[242:243]
    v_pk_mul_f32 v[232:233], v[232:233], v[234:235]
    v_cvt_pk_bf16_f32 v216, v236, v237
    v_cvt_pk_bf16_f32 v217, v240, v241
    v_cvt_pk_bf16_f32 v218, v232, v233
    v_accvgpr_read_b32 v237, a181
    v_accvgpr_read_b32 v239, a159
    v_accvgpr_read_b32 v241, a170
    v_accvgpr_read_b32 v243, a160
    v_accvgpr_read_b32 v233, a174
    v_accvgpr_read_b32 v235, a161
    v_lshlrev_b32 v236, 16, v237
    v_lshlrev_b32 v238, 16, v239
    v_lshlrev_b32 v240, 16, v241
    v_lshlrev_b32 v242, 16, v243
    v_lshlrev_b32 v232, 16, v233
    v_lshlrev_b32 v234, 16, v235
    v_and_b32 v237, 0xffff0000, v237
    v_and_b32 v239, 0xffff0000, v239
    v_and_b32 v241, 0xffff0000, v241
    v_and_b32 v243, 0xffff0000, v243
    v_and_b32 v233, 0xffff0000, v233
    v_and_b32 v235, 0xffff0000, v235
    v_pk_mul_f32 v[236:237], v[236:237], v[238:239]
    v_pk_mul_f32 v[240:241], v[240:241], v[242:243]
    v_pk_mul_f32 v[232:233], v[232:233], v[234:235]
    v_cvt_pk_bf16_f32 v219, v236, v237
    v_cvt_pk_bf16_f32 v220, v240, v241
    v_cvt_pk_bf16_f32 v221, v232, v233
    v_accvgpr_read_b32 v237, a178
    v_accvgpr_read_b32 v239, a162
    v_accvgpr_read_b32 v241, a182
    v_accvgpr_read_b32 v243, a163
    v_accvgpr_read_b32 v233, a171
    v_accvgpr_read_b32 v235, a164
    v_lshlrev_b32 v236, 16, v237
    v_lshlrev_b32 v238, 16, v239
    v_lshlrev_b32 v240, 16, v241
    v_lshlrev_b32 v242, 16, v243
    v_lshlrev_b32 v232, 16, v233
    v_lshlrev_b32 v234, 16, v235
    v_and_b32 v237, 0xffff0000, v237
    v_and_b32 v239, 0xffff0000, v239
    v_and_b32 v241, 0xffff0000, v241
    v_and_b32 v243, 0xffff0000, v243
    v_and_b32 v233, 0xffff0000, v233
    v_and_b32 v235, 0xffff0000, v235
    v_pk_mul_f32 v[236:237], v[236:237], v[238:239]
    v_pk_mul_f32 v[240:241], v[240:241], v[242:243]
    v_pk_mul_f32 v[232:233], v[232:233], v[234:235]
    v_cvt_pk_bf16_f32 v222, v236, v237
    v_cvt_pk_bf16_f32 v223, v240, v241
    v_cvt_pk_bf16_f32 v224, v232, v233
    v_accvgpr_read_b32 v237, a175
    v_accvgpr_read_b32 v239, a165
    v_accvgpr_read_b32 v241, a179
    v_accvgpr_read_b32 v243, a166
    v_accvgpr_read_b32 v233, a183
    v_accvgpr_read_b32 v235, a167
    v_lshlrev_b32 v236, 16, v237
    v_lshlrev_b32 v238, 16, v239
    v_lshlrev_b32 v240, 16, v241
    v_lshlrev_b32 v242, 16, v243
    v_lshlrev_b32 v232, 16, v233
    v_lshlrev_b32 v234, 16, v235
    v_mov_b32 v211, 0x3f803f80
    v_and_b32 v237, 0xffff0000, v237
    v_and_b32 v239, 0xffff0000, v239
    v_and_b32 v241, 0xffff0000, v241
    v_and_b32 v243, 0xffff0000, v243
    v_and_b32 v233, 0xffff0000, v233
    v_and_b32 v235, 0xffff0000, v235
    v_dot2_f32_bf16 v228, v212, v211, 0
    v_dot2_f32_bf16 v229, v213, v211, 0
    v_dot2_f32_bf16 v230, v214, v211, 0
    v_dot2_f32_bf16 v231, v215, v211, 0
    v_pk_mul_f32 v[236:237], v[236:237], v[238:239]
    v_pk_mul_f32 v[240:241], v[240:241], v[242:243]
    v_pk_mul_f32 v[232:233], v[232:233], v[234:235]
    v_dot2_f32_bf16 v228, v216, v211, v228
    v_dot2_f32_bf16 v229, v217, v211, v229
    v_dot2_f32_bf16 v230, v218, v211, v230
    v_dot2_f32_bf16 v231, v219, v211, v231
    v_cvt_pk_bf16_f32 v225, v236, v237
    v_cvt_pk_bf16_f32 v226, v240, v241
    v_cvt_pk_bf16_f32 v227, v232, v233
    v_dot2_f32_bf16 v228, v220, v211, v228
    v_dot2_f32_bf16 v229, v221, v211, v229
    v_dot2_f32_bf16 v230, v222, v211, v230
    v_dot2_f32_bf16 v231, v223, v211, v231
    v_dot2_f32_bf16 v228, v224, v211, v228
    v_dot2_f32_bf16 v229, v225, v211, v229
    v_dot2_f32_bf16 v230, v226, v211, v230
    v_dot2_f32_bf16 v231, v227, v211, v231
    ds_read_b128 v[28:31], v197 offset:16384
    v_add_f32 v228, v228, v229
    s_nop 0
    v_add_f32 v230, v230, v231
    v_add_f32 v228, v228, v230
    ds_read_b128 v[32:35], v197 offset:17408
    s_nop 0
    v_add_f32_dpp v228, v228, v228 quad_perm:[2,3,0,1] row_mask:0xf bank_mask:0xf
    ds_read_b128 v[36:39], v197 offset:18432
    s_nop 0
    v_add_f32_dpp v228, v228, v228 row_ror:4 row_mask:0xf bank_mask:0xf
    ds_read_b128 v[40:43], v197 offset:19456
    s_nop 0
    v_add_f32_dpp v228, v228, v228 row_ror:8 row_mask:0xf bank_mask:0xf
    v_mov_b32 v229, v228
    s_nop 1
    v_permlane16_swap_b32 v228, v229
    v_add_f32 v228, v228, v229
    v_mov_b32 v229, v228
    s_nop 1
    v_permlane32_swap_b32 v228, v229
    v_add_f32 v228, v228, v229
    v_cvt_pk_bf16_f32 v228, v228, v228
    v_lshlrev_b32 v228, 16, v228
    v_mul_f32 v228, 0xbfb8aa3b, v228
    v_exp_f32 v228, v228
    s_nop 0
    v_add_f32 v228, 1.0, v228
    v_rcp_f32 v228, v228
    s_nop 0
    v_cvt_pk_bf16_f32 v228, v228, v228
    v_lshlrev_b32 v211, 16, v228
    s_nop 0
    v_readlane_b32 s32, v211, 0
    v_readlane_b32 s33, v211, 1
    s_nop 0
    v_sub_f32 v192, 1.0, s32
    v_sub_f32 v193, 1.0, s33
    v_cvt_pk_bf16_f32 v192, v192, v192
    v_cvt_pk_bf16_f32 v193, v193, v193
    v_lshlrev_b32 v192, 16, v192
    v_lshlrev_b32 v193, 16, v193
    v_mul_f32 v192, 0x35800000, v192
    v_mul_f32 v193, 0x35800000, v193
    v_pk_mul_f32 v[92:93], v[192:193], v[84:85] op_sel:[1,0] op_sel_hi:[1,1]
    v_pk_mul_f32 v[108:109], v[192:193], v[100:101] op_sel:[1,0] op_sel_hi:[1,1]
    v_pk_mul_f32 v[94:95], v[192:193], v[86:87] op_sel:[1,0] op_sel_hi:[1,1]
    v_pk_mul_f32 v[110:111], v[192:193], v[102:103] op_sel:[1,0] op_sel_hi:[1,1]
    v_pk_mul_f32 v[96:97], v[192:193], v[88:89] op_sel:[1,0] op_sel_hi:[1,1]
    v_pk_mul_f32 v[112:113], v[192:193], v[104:105] op_sel:[1,0] op_sel_hi:[1,1]
    v_pk_mul_f32 v[98:99], v[192:193], v[90:91] op_sel:[1,0] op_sel_hi:[1,1]
    v_pk_mul_f32 v[114:115], v[192:193], v[106:107] op_sel:[1,0] op_sel_hi:[1,1]
    s_lshr_b32 s32, s32, 16
    v_pk_mul_f32 v[84:85], v[84:85], v[192:193] op_sel:[0,0] op_sel_hi:[1,0]
    v_pk_mul_f32 v[100:101], v[100:101], v[192:193] op_sel:[0,0] op_sel_hi:[1,0]
    v_pk_mul_f32 v[86:87], v[86:87], v[192:193] op_sel:[0,0] op_sel_hi:[1,0]
    v_pk_mul_f32 v[102:103], v[102:103], v[192:193] op_sel:[0,0] op_sel_hi:[1,0]
    v_pk_mul_f32 v[88:89], v[88:89], v[192:193] op_sel:[0,0] op_sel_hi:[1,0]
    v_pk_mul_f32 v[104:105], v[104:105], v[192:193] op_sel:[0,0] op_sel_hi:[1,0]
    v_pk_mul_f32 v[90:91], v[90:91], v[192:193] op_sel:[0,0] op_sel_hi:[1,0]
    v_pk_mul_f32 v[106:107], v[106:107], v[192:193] op_sel:[0,0] op_sel_hi:[1,0]
    s_waitcnt lgkmcnt(3)
    v_dot2_f32_bf16 v116, v28, s32, 0
    v_dot2_f32_bf16 v120, v29, s32, 0
    v_dot2_f32_bf16 v124, v30, s32, 0
    v_dot2_f32_bf16 v128, v31, s32, 0
    s_waitcnt lgkmcnt(2)
    v_dot2_f32_bf16 v117, v32, s32, 0
    v_dot2_f32_bf16 v121, v33, s32, 0
    v_dot2_f32_bf16 v125, v34, s32, 0
    v_dot2_f32_bf16 v129, v35, s32, 0
    s_waitcnt lgkmcnt(1)
    v_dot2_f32_bf16 v118, v36, s32, 0
    v_dot2_f32_bf16 v122, v37, s32, 0
    v_dot2_f32_bf16 v126, v38, s32, 0
    v_dot2_f32_bf16 v130, v39, s32, 0
    s_waitcnt lgkmcnt(0)
    v_dot2_f32_bf16 v119, v40, s32, 0
    v_dot2_f32_bf16 v123, v41, s32, 0
    v_dot2_f32_bf16 v127, v42, s32, 0
    v_dot2_f32_bf16 v131, v43, s32, 0
    v_dot2_f32_bf16 v132, v28, s33, 0
    v_dot2_f32_bf16 v136, v29, s33, 0
    v_dot2_f32_bf16 v140, v30, s33, 0
    v_dot2_f32_bf16 v144, v31, s33, 0
    v_dot2_f32_bf16 v133, v32, s33, 0
    v_dot2_f32_bf16 v137, v33, s33, 0
    v_dot2_f32_bf16 v141, v34, s33, 0
    v_dot2_f32_bf16 v145, v35, s33, 0
    v_dot2_f32_bf16 v134, v36, s33, 0
    v_dot2_f32_bf16 v138, v37, s33, 0
    v_dot2_f32_bf16 v142, v38, s33, 0
    v_dot2_f32_bf16 v146, v39, s33, 0
    v_dot2_f32_bf16 v135, v40, s33, 0
    v_dot2_f32_bf16 v139, v41, s33, 0
    v_dot2_f32_bf16 v143, v42, s33, 0
    v_dot2_f32_bf16 v147, v43, s33, 0
    s_mov_b32 s57, 0x20000
    s_waitcnt vmcnt(0)
    s_branch tc_14
tl_13:
    buffer_load_dwordx4 v[12:15], v196, s[4:7], s23 offen sc1
    buffer_load_dwordx4 v[16:19], v196, s[4:7], s23 offen offset:2048 sc1
    buffer_load_dwordx4 v[20:23], v196, s[4:7], s24 offen sc1
    buffer_load_dwordx4 v[24:27], v196, s[4:7], s24 offen offset:2048 sc1
    s_waitcnt vmcnt(0)
tc_14:
    v_xor_b32 v4, v12, v244
    v_xor_b32 v5, v13, v245
    v_xor_b32 v6, v14, v246
    v_xor_b32 v7, v15, v247
    v_bitop3_b32 v4, v4, v16, v244 bitop3:0xf6
    v_bitop3_b32 v5, v5, v17, v245 bitop3:0xf6
    v_bitop3_b32 v6, v6, v18, v246 bitop3:0xf6
    v_bitop3_b32 v7, v7, v19, v247 bitop3:0xf6
    v_bitop3_b32 v4, v4, v20, v244 bitop3:0xf6
    v_bitop3_b32 v5, v5, v21, v245 bitop3:0xf6
    v_bitop3_b32 v6, v6, v22, v246 bitop3:0xf6
    v_bitop3_b32 v7, v7, v23, v247 bitop3:0xf6
    v_bitop3_b32 v4, v4, v24, v244 bitop3:0xf6
    v_bitop3_b32 v5, v5, v25, v245 bitop3:0xf6
    v_bitop3_b32 v6, v6, v26, v246 bitop3:0xf6
    v_bitop3_b32 v7, v7, v27, v247 bitop3:0xf6
    v_or3_b32 v4, v4, v5, v6
    v_or_b32 v4, v4, v7
    v_and_b32 v4, s55, v4
    s_nop 1
    v_or_b32_dpp v4, v4, v4 quad_perm:[1,0,3,2] row_mask:0xf bank_mask:0xf
    v_mov_b32 v5, v4
    s_nop 1
    v_permlane32_swap_b32 v4, v5
    v_or_b32 v4, v4, v5
    v_cmp_ne_u32 vcc, 0, v4
    s_nop 0
    s_and_b64 exec, exec, vcc
    s_cbranch_scc0 td_15
    s_sub_u32 s57, s57, 1
    s_cbranch_scc0 tl_13
td_15:
    s_mov_b64 exec, -1
    s_branch k_z2done
k_z2x:
    buffer_load_dwordx4 v[12:15], v196, s[4:7], s23 offen sc1
    buffer_load_dwordx4 v[16:19], v196, s[4:7], s23 offen offset:2048 sc1
    buffer_load_dwordx4 v[20:23], v196, s[4:7], s24 offen sc1
    buffer_load_dwordx4 v[24:27], v196, s[4:7], s24 offen offset:2048 sc1
    buffer_load_dwordx2 v[44:45], v198, s[4:7], s25 offen sc1
    buffer_load_dwordx2 v[46:47], v198, s[4:7], s25 offen offset:2048 sc1
    buffer_load_dwordx2 v[48:49], v198, s[4:7], s27 offen sc1
    buffer_load_dwordx2 v[50:51], v198, s[4:7], s27 offen offset:2048 sc1
    v_accvgpr_read_b32 v233, a168
    v_accvgpr_read_b32 v235, a152
    v_lshlrev_b32 v232, 16, v233
    v_lshlrev_b32 v234, 16, v235
    v_and_b32 v233, 0xffff0000, v233
    v_and_b32 v235, 0xffff0000, v235
    v_pk_mul_f32 v[232:233], v[232:233], v[234:235]
    v_cvt_pk_bf16_f32 v212, v232, v233
    v_accvgpr_read_b32 v237, a172
    v_accvgpr_read_b32 v239, a153
    v_accvgpr_read_b32 v241, a176
    v_accvgpr_read_b32 v243, a154
    v_accvgpr_read_b32 v233, a180
    v_accvgpr_read_b32 v235, a155
    v_lshlrev_b32 v236, 16, v237
    v_lshlrev_b32 v238, 16, v239
    v_lshlrev_b32 v240, 16, v241
    v_lshlrev_b32 v242, 16, v243
    v_lshlrev_b32 v232, 16, v233
    v_lshlrev_b32 v234, 16, v235
    v_and_b32 v237, 0xffff0000, v237
    v_and_b32 v239, 0xffff0000, v239
    v_and_b32 v241, 0xffff0000, v241
    v_and_b32 v243, 0xffff0000, v243
    v_and_b32 v233, 0xffff0000, v233
    v_and_b32 v235, 0xffff0000, v235
    v_pk_mul_f32 v[236:237], v[236:237], v[238:239]
    v_pk_mul_f32 v[240:241], v[240:241], v[242:243]
    v_pk_mul_f32 v[232:233], v[232:233], v[234:235]
    v_cvt_pk_bf16_f32 v213, v236, v237
    v_cvt_pk_bf16_f32 v214, v240, v241
    v_cvt_pk_bf16_f32 v215, v232, v233
    v_accvgpr_read_b32 v237, a169
    v_accvgpr_read_b32 v239, a156
    v_accvgpr_read_b32 v241, a173
    v_accvgpr_read_b32 v243, a157
    v_accvgpr_read_b32 v233, a177
    v_accvgpr_read_b32 v235, a158
    v_lshlrev_b32 v236, 16, v237
    v_lshlrev_b32 v238, 16, v239
    v_lshlrev_b32 v240, 16, v241
    v_lshlrev_b32 v242, 16, v243
    v_lshlrev_b32 v232, 16, v233
    v_lshlrev_b32 v234, 16, v235
    v_and_b32 v237, 0xffff0000, v237
    v_and_b32 v239, 0xffff0000, v239
    v_and_b32 v241, 0xffff0000, v241
    v_and_b32 v243, 0xffff0000, v243
    v_and_b32 v233, 0xffff0000, v233
    v_and_b32 v235, 0xffff0000, v235
    v_pk_mul_f32 v[236:237], v[236:237], v[238:239]
    v_pk_mul_f32 v[240:241], v[240:241], v[242:243]
    v_pk_mul_f32 v[232:233], v[232:233], v[234:235]
    v_cvt_pk_bf16_f32 v216, v236, v237
    v_cvt_pk_bf16_f32 v217, v240, v241
    v_cvt_pk_bf16_f32 v218, v232, v233
    v_accvgpr_read_b32 v237, a181
    v_accvgpr_read_b32 v239, a159
    v_accvgpr_read_b32 v241, a170
    v_accvgpr_read_b32 v243, a160
    v_accvgpr_read_b32 v233, a174
    v_accvgpr_read_b32 v235, a161
    v_lshlrev_b32 v236, 16, v237
    v_lshlrev_b32 v238, 16, v239
    v_lshlrev_b32 v240, 16, v241
    v_lshlrev_b32 v242, 16, v243
    v_lshlrev_b32 v232, 16, v233
    v_lshlrev_b32 v234, 16, v235
    v_and_b32 v237, 0xffff0000, v237
    v_and_b32 v239, 0xffff0000, v239
    v_and_b32 v241, 0xffff0000, v241
    v_and_b32 v243, 0xffff0000, v243
    v_and_b32 v233, 0xffff0000, v233
    v_and_b32 v235, 0xffff0000, v235
    v_pk_mul_f32 v[236:237], v[236:237], v[238:239]
    v_pk_mul_f32 v[240:241], v[240:241], v[242:243]
    v_pk_mul_f32 v[232:233], v[232:233], v[234:235]
    v_cvt_pk_bf16_f32 v219, v236, v237
    v_cvt_pk_bf16_f32 v220, v240, v241
    v_cvt_pk_bf16_f32 v221, v232, v233
    v_accvgpr_read_b32 v237, a178
    v_accvgpr_read_b32 v239, a162
    v_accvgpr_read_b32 v241, a182
    v_accvgpr_read_b32 v243, a163
    v_accvgpr_read_b32 v233, a171
    v_accvgpr_read_b32 v235, a164
    v_lshlrev_b32 v236, 16, v237
    v_lshlrev_b32 v238, 16, v239
    v_lshlrev_b32 v240, 16, v241
    v_lshlrev_b32 v242, 16, v243
    v_lshlrev_b32 v232, 16, v233
    v_lshlrev_b32 v234, 16, v235
    v_and_b32 v237, 0xffff0000, v237
    v_and_b32 v239, 0xffff0000, v239
    v_and_b32 v241, 0xffff0000, v241
    v_and_b32 v243, 0xffff0000, v243
    v_and_b32 v233, 0xffff0000, v233
    v_and_b32 v235, 0xffff0000, v235
    v_pk_mul_f32 v[236:237], v[236:237], v[238:239]
    v_pk_mul_f32 v[240:241], v[240:241], v[242:243]
    v_pk_mul_f32 v[232:233], v[232:233], v[234:235]
    v_cvt_pk_bf16_f32 v222, v236, v237
    v_cvt_pk_bf16_f32 v223, v240, v241
    v_cvt_pk_bf16_f32 v224, v232, v233
    v_accvgpr_read_b32 v237, a175
    v_accvgpr_read_b32 v239, a165
    v_accvgpr_read_b32 v241, a179
    v_accvgpr_read_b32 v243, a166
    v_accvgpr_read_b32 v233, a183
    v_accvgpr_read_b32 v235, a167
    v_lshlrev_b32 v236, 16, v237
    v_lshlrev_b32 v238, 16, v239
    v_lshlrev_b32 v240, 16, v241
    v_lshlrev_b32 v242, 16, v243
    v_lshlrev_b32 v232, 16, v233
    v_lshlrev_b32 v234, 16, v235
    v_mov_b32 v211, 0x3f803f80
    v_and_b32 v237, 0xffff0000, v237
    v_and_b32 v239, 0xffff0000, v239
    v_and_b32 v241, 0xffff0000, v241
    v_and_b32 v243, 0xffff0000, v243
    v_and_b32 v233, 0xffff0000, v233
    v_and_b32 v235, 0xffff0000, v235
    v_dot2_f32_bf16 v228, v212, v211, 0
    v_dot2_f32_bf16 v229, v213, v211, 0
    v_dot2_f32_bf16 v230, v214, v211, 0
    v_dot2_f32_bf16 v231, v215, v211, 0
    v_pk_mul_f32 v[236:237], v[236:237], v[238:239]
    v_pk_mul_f32 v[240:241], v[240:241], v[242:243]
    v_pk_mul_f32 v[232:233], v[232:233], v[234:235]
    v_dot2_f32_bf16 v228, v216, v211, v228
    v_dot2_f32_bf16 v229, v217, v211, v229
    v_dot2_f32_bf16 v230, v218, v211, v230
    v_dot2_f32_bf16 v231, v219, v211, v231
    v_cvt_pk_bf16_f32 v225, v236, v237
    v_cvt_pk_bf16_f32 v226, v240, v241
    v_cvt_pk_bf16_f32 v227, v232, v233
    v_dot2_f32_bf16 v228, v220, v211, v228
    v_dot2_f32_bf16 v229, v221, v211, v229
    v_dot2_f32_bf16 v230, v222, v211, v230
    v_dot2_f32_bf16 v231, v223, v211, v231
    v_dot2_f32_bf16 v228, v224, v211, v228
    v_dot2_f32_bf16 v229, v225, v211, v229
    v_dot2_f32_bf16 v230, v226, v211, v230
    v_dot2_f32_bf16 v231, v227, v211, v231
    ds_read_b128 v[28:31], v197 offset:16384
    v_add_f32 v228, v228, v229
    s_nop 0
    v_add_f32 v230, v230, v231
    v_add_f32 v228, v228, v230
    ds_read_b128 v[32:35], v197 offset:17408
    s_nop 0
    v_add_f32_dpp v228, v228, v228 quad_perm:[2,3,0,1] row_mask:0xf bank_mask:0xf
    ds_read_b128 v[36:39], v197 offset:18432
    s_nop 0
    v_add_f32_dpp v228, v228, v228 row_ror:4 row_mask:0xf bank_mask:0xf
    ds_read_b128 v[40:43], v197 offset:19456
    s_nop 0
    v_add_f32_dpp v228, v228, v228 row_ror:8 row_mask:0xf bank_mask:0xf
    v_mov_b32 v229, v228
    s_nop 1
    v_permlane16_swap_b32 v228, v229
    v_add_f32 v228, v228, v229
    v_mov_b32 v229, v228
    s_nop 1
    v_permlane32_swap_b32 v228, v229
    v_add_f32 v228, v228, v229
    v_cvt_pk_bf16_f32 v228, v228, v228
    v_lshlrev_b32 v228, 16, v228
    v_mul_f32 v228, 0xbfb8aa3b, v228
    v_exp_f32 v228, v228
    s_nop 0
    v_add_f32 v228, 1.0, v228
    v_rcp_f32 v228, v228
    s_nop 0
    v_cvt_pk_bf16_f32 v228, v228, v228
    v_lshlrev_b32 v211, 16, v228
    s_nop 0
    v_readlane_b32 s32, v211, 0
    v_readlane_b32 s33, v211, 1
    s_nop 0
    v_sub_f32 v192, 1.0, s32
    v_sub_f32 v193, 1.0, s33
    v_cvt_pk_bf16_f32 v192, v192, v192
    v_cvt_pk_bf16_f32 v193, v193, v193
    v_lshlrev_b32 v192, 16, v192
    v_lshlrev_b32 v193, 16, v193
    v_mul_f32 v192, 0x35800000, v192
    v_mul_f32 v193, 0x35800000, v193
    v_pk_mul_f32 v[92:93], v[192:193], v[84:85] op_sel:[1,0] op_sel_hi:[1,1]
    v_pk_mul_f32 v[108:109], v[192:193], v[100:101] op_sel:[1,0] op_sel_hi:[1,1]
    v_pk_mul_f32 v[94:95], v[192:193], v[86:87] op_sel:[1,0] op_sel_hi:[1,1]
    v_pk_mul_f32 v[110:111], v[192:193], v[102:103] op_sel:[1,0] op_sel_hi:[1,1]
    v_pk_mul_f32 v[96:97], v[192:193], v[88:89] op_sel:[1,0] op_sel_hi:[1,1]
    v_pk_mul_f32 v[112:113], v[192:193], v[104:105] op_sel:[1,0] op_sel_hi:[1,1]
    v_pk_mul_f32 v[98:99], v[192:193], v[90:91] op_sel:[1,0] op_sel_hi:[1,1]
    v_pk_mul_f32 v[114:115], v[192:193], v[106:107] op_sel:[1,0] op_sel_hi:[1,1]
    s_lshr_b32 s32, s32, 16
    v_pk_mul_f32 v[84:85], v[84:85], v[192:193] op_sel:[0,0] op_sel_hi:[1,0]
    v_pk_mul_f32 v[100:101], v[100:101], v[192:193] op_sel:[0,0] op_sel_hi:[1,0]
    v_pk_mul_f32 v[86:87], v[86:87], v[192:193] op_sel:[0,0] op_sel_hi:[1,0]
    v_pk_mul_f32 v[102:103], v[102:103], v[192:193] op_sel:[0,0] op_sel_hi:[1,0]
    v_pk_mul_f32 v[88:89], v[88:89], v[192:193] op_sel:[0,0] op_sel_hi:[1,0]
    v_pk_mul_f32 v[104:105], v[104:105], v[192:193] op_sel:[0,0] op_sel_hi:[1,0]
    v_pk_mul_f32 v[90:91], v[90:91], v[192:193] op_sel:[0,0] op_sel_hi:[1,0]
    v_pk_mul_f32 v[106:107], v[106:107], v[192:193] op_sel:[0,0] op_sel_hi:[1,0]
    s_waitcnt lgkmcnt(3)
    v_dot2_f32_bf16 v116, v28, s32, 0
    v_dot2_f32_bf16 v120, v29, s32, 0
    v_dot2_f32_bf16 v124, v30, s32, 0
    v_dot2_f32_bf16 v128, v31, s32, 0
    s_waitcnt lgkmcnt(2)
    v_dot2_f32_bf16 v117, v32, s32, 0
    v_dot2_f32_bf16 v121, v33, s32, 0
    v_dot2_f32_bf16 v125, v34, s32, 0
    v_dot2_f32_bf16 v129, v35, s32, 0
    s_waitcnt lgkmcnt(1)
    v_dot2_f32_bf16 v118, v36, s32, 0
    v_dot2_f32_bf16 v122, v37, s32, 0
    v_dot2_f32_bf16 v126, v38, s32, 0
    v_dot2_f32_bf16 v130, v39, s32, 0
    s_waitcnt lgkmcnt(0)
    v_dot2_f32_bf16 v119, v40, s32, 0
    v_dot2_f32_bf16 v123, v41, s32, 0
    v_dot2_f32_bf16 v127, v42, s32, 0
    v_dot2_f32_bf16 v131, v43, s32, 0
    v_dot2_f32_bf16 v132, v28, s33, 0
    v_dot2_f32_bf16 v136, v29, s33, 0
    v_dot2_f32_bf16 v140, v30, s33, 0
    v_dot2_f32_bf16 v144, v31, s33, 0
    v_dot2_f32_bf16 v133, v32, s33, 0
    v_dot2_f32_bf16 v137, v33, s33, 0
    v_dot2_f32_bf16 v141, v34, s33, 0
    v_dot2_f32_bf16 v145, v35, s33, 0
    v_dot2_f32_bf16 v134, v36, s33, 0
    v_dot2_f32_bf16 v138, v37, s33, 0
    v_dot2_f32_bf16 v142, v38, s33, 0
    v_dot2_f32_bf16 v146, v39, s33, 0
    v_dot2_f32_bf16 v135, v40, s33, 0
    v_dot2_f32_bf16 v139, v41, s33, 0
    v_dot2_f32_bf16 v143, v42, s33, 0
    v_dot2_f32_bf16 v147, v43, s33, 0
    s_mov_b32 s57, 0x20000
    s_waitcnt vmcnt(0)
    s_branch tc_17
tl_16:
    buffer_load_dwordx4 v[12:15], v196, s[4:7], s23 offen sc1
    buffer_load_dwordx4 v[16:19], v196, s[4:7], s23 offen offset:2048 sc1
    buffer_load_dwordx4 v[20:23], v196, s[4:7], s24 offen sc1
    buffer_load_dwordx4 v[24:27], v196, s[4:7], s24 offen offset:2048 sc1
    buffer_load_dwordx2 v[44:45], v198, s[4:7], s25 offen sc1
    buffer_load_dwordx2 v[46:47], v198, s[4:7], s25 offen offset:2048 sc1
    buffer_load_dwordx2 v[48:49], v198, s[4:7], s27 offen sc1
    buffer_load_dwordx2 v[50:51], v198, s[4:7], s27 offen offset:2048 sc1
    s_waitcnt vmcnt(0)
tc_17:
    v_xor_b32 v4, v12, v244
    v_xor_b32 v5, v13, v245
    v_xor_b32 v6, v14, v246
    v_xor_b32 v7, v15, v247
    v_bitop3_b32 v4, v4, v16, v244 bitop3:0xf6
    v_bitop3_b32 v5, v5, v17, v245 bitop3:0xf6
    v_bitop3_b32 v6, v6, v18, v246 bitop3:0xf6
    v_bitop3_b32 v7, v7, v19, v247 bitop3:0xf6
    v_bitop3_b32 v4, v4, v20, v244 bitop3:0xf6
    v_bitop3_b32 v5, v5, v21, v245 bitop3:0xf6
    v_bitop3_b32 v6, v6, v22, v246 bitop3:0xf6
    v_bitop3_b32 v7, v7, v23, v247 bitop3:0xf6
    v_bitop3_b32 v4, v4, v24, v244 bitop3:0xf6
    v_bitop3_b32 v5, v5, v25, v245 bitop3:0xf6
    v_bitop3_b32 v6, v6, v26, v246 bitop3:0xf6
    v_bitop3_b32 v7, v7, v27, v247 bitop3:0xf6
    v_or3_b32 v4, v4, v5, v6
    v_or_b32 v4, v4, v7
    v_and_b32 v4, s55, v4
    v_xor_b32 v5, s56, v45
    v_or_b32 v4, v4, v5
    v_xor_b32 v5, s56, v47
    v_or_b32 v4, v4, v5
    v_xor_b32 v5, s56, v49
    v_or_b32 v4, v4, v5
    v_xor_b32 v5, s56, v51
    v_or_b32 v4, v4, v5
    s_nop 1
    v_or_b32_dpp v4, v4, v4 quad_perm:[1,0,3,2] row_mask:0xf bank_mask:0xf
    v_mov_b32 v5, v4
    s_nop 1
    v_permlane32_swap_b32 v4, v5
    v_or_b32 v4, v4, v5
    v_cmp_ne_u32 vcc, 0, v4
    s_nop 0
    s_and_b64 exec, exec, vcc
    s_cbranch_scc0 td_18
    s_sub_u32 s57, s57, 1
    s_cbranch_scc0 tl_16
td_18:
    s_mov_b64 exec, -1
    v_mov_b32 v45, v46
    v_mov_b32 v46, v48
    v_mov_b32 v47, v50
    s_nop 1
    v_mfma_f32_16x16x32_bf16 v[212:215], v[52:55], v[44:47], 0
    v_mfma_f32_16x16x32_bf16 v[216:219], v[56:59], v[44:47], 0
    s_mov_b32 s58, 0x10001
    s_mov_b32 s59, s58
    s_nop 5
    v_cvt_pk_bf16_f32 v220, v214, v218
    v_cvt_pk_bf16_f32 v221, v215, v219
    s_mov_b64 exec, s[58:59]
    ds_write_b64 v191, v[220:221] offset:2048
    s_mov_b64 exec, -1
k_z2done:
    v_swap_b32 v13, v16
    v_swap_b32 v14, v20
    v_swap_b32 v15, v24
    v_swap_b32 v18, v21
    s_nop 0
    v_mfma_f32_16x16x32_bf16 v[152:155], v[52:55], v[12:15], 0
    v_swap_b32 v19, v25
    v_mfma_f32_16x16x32_bf16 v[156:159], v[56:59], v[12:15], 0
    v_swap_b32 v23, v26
    v_mfma_f32_16x16x32_bf16 v[160:163], v[52:55], v[16:19], 0
    v_mfma_f32_16x16x32_bf16 v[164:167], v[56:59], v[16:19], 0
    s_nop 4
    v_cvt_pk_bf16_f32 v230, v154, v158
    v_cvt_pk_bf16_f32 v231, v155, v159
    ds_write_b64 v188, v[230:231] offset:0
    v_pk_add_f32 v[224:225], v[154:155], v[152:153] neg_lo:[0,1] neg_hi:[0,1]
    v_pk_add_f32 v[226:227], v[158:159], v[156:157] neg_lo:[0,1] neg_hi:[0,1]
    v_pk_fma_f32 v[152:153], v[224:225], v[194:195], v[152:153] op_sel:[0,0,0] op_sel_hi:[1,0,1]
    v_pk_fma_f32 v[156:157], v[226:227], v[194:195], v[156:157] op_sel:[0,0,0] op_sel_hi:[1,0,1]
    v_cvt_pk_bf16_f32 v228, v152, v156
    v_cvt_pk_bf16_f32 v229, v153, v157
    ds_write_b64 v184, v[228:229] offset:0
    v_mfma_f32_16x16x32_bf16 v[168:171], v[52:55], v[20:23], 0
    v_cvt_pk_bf16_f32 v234, v162, v166
    v_cvt_pk_bf16_f32 v235, v163, v167
    v_mfma_f32_16x16x32_bf16 v[172:175], v[56:59], v[20:23], 0
    ds_write_b64 v187, v[234:235] offset:12288
    v_cvt_pk_bf16_f32 v232, v160, v164
    v_cvt_pk_bf16_f32 v233, v161, v165
    ds_write_b64 v185, v[232:233] offset:4096
    v_mfma_f32_16x16x32_bf16 v[176:179], v[52:55], v[24:27], 0
    s_nop 2
    v_cvt_pk_bf16_f32 v238, v170, v174
    v_cvt_pk_bf16_f32 v239, v171, v175
    v_mfma_f32_16x16x32_bf16 v[180:183], v[56:59], v[24:27], 0
    ds_write_b64 v186, v[238:239] offset:8192
    v_cvt_pk_bf16_f32 v236, v168, v172
    v_cvt_pk_bf16_f32 v237, v169, v173
    ds_write_b64 v184, v[236:237] offset:8192
    s_nop 3
    v_cvt_pk_bf16_f32 v242, v178, v182
    v_cvt_pk_bf16_f32 v243, v179, v183
    ds_write_b64 v187, v[242:243] offset:4096
    v_cvt_pk_bf16_f32 v240, v176, v180
    v_cvt_pk_bf16_f32 v241, v177, v181
    ds_write_b64 v185, v[240:241] offset:12288
    s_waitcnt lgkmcnt(0)
    s_barrier
    ds_read_b64 v[12:13], v190 offset:0
    ds_read_b64 v[16:17], v190 offset:512
    ds_read_b64 v[14:15], v190 offset:1024
    ds_read_b64 v[18:19], v190 offset:1536
    ds_read_b64 v[20:21], v190 offset:2048
    ds_read_b64 v[24:25], v190 offset:2560
    ds_read_b64 v[22:23], v190 offset:3072
    ds_read_b64 v[26:27], v190 offset:3584
    s_waitcnt lgkmcnt(6)
    v_swap_b32 v13, v16
    s_waitcnt lgkmcnt(4)
    v_swap_b32 v15, v18
    s_waitcnt lgkmcnt(2)
    v_swap_b32 v21, v24
    v_mfma_f32_16x16x32_bf16 v[152:155], v[12:15], v[60:63], 0
    s_waitcnt lgkmcnt(0)
    v_swap_b32 v23, v26
    v_mfma_f32_16x16x32_bf16 v[156:159], v[12:15], v[64:67], 0
    v_mfma_f32_16x16x32_bf16 v[160:163], v[12:15], v[68:71], 0
    v_mfma_f32_16x16x32_bf16 v[164:167], v[12:15], v[72:75], 0
    v_mfma_f32_16x16x32_bf16 v[152:155], v[20:23], v[60:63], v[152:155]
    v_mfma_f32_16x16x32_bf16 v[156:159], v[20:23], v[64:67], v[156:159]
    v_mfma_f32_16x16x32_bf16 v[160:163], v[20:23], v[76:79], v[160:163]
    v_mfma_f32_16x16x32_bf16 v[164:167], v[20:23], v[80:83], v[164:167]
    v_mfma_f32_16x16x32_bf16 v[168:171], v[16:19], v[60:63], 0
    v_mfma_f32_16x16x32_bf16 v[172:175], v[16:19], v[64:67], 0
    v_mfma_f32_16x16x32_bf16 v[176:179], v[16:19], v[68:71], 0
    v_mfma_f32_16x16x32_bf16 v[180:183], v[16:19], v[72:75], 0
    v_mfma_f32_16x16x32_bf16 v[168:171], v[24:27], v[60:63], v[168:171]
    v_mfma_f32_16x16x32_bf16 v[172:175], v[24:27], v[64:67], v[172:175]
    v_mfma_f32_16x16x32_bf16 v[176:179], v[24:27], v[76:79], v[176:179]
    v_mfma_f32_16x16x32_bf16 v[180:183], v[24:27], v[80:83], v[180:183]
    v_pk_mul_f32 v[212:213], v[152:153], v[84:85]
    v_pk_mul_f32 v[214:215], v[156:157], v[84:85]
    v_pk_mul_f32 v[216:217], v[154:155], v[86:87]
    v_pk_mul_f32 v[218:219], v[158:159], v[86:87]
    v_pk_mul_f32 v[220:221], v[160:161], v[88:89]
    v_pk_mul_f32 v[222:223], v[164:165], v[88:89]
    v_pk_mul_f32 v[224:225], v[162:163], v[90:91]
    v_pk_mul_f32 v[226:227], v[166:167], v[90:91]
    v_pk_fma_f32 v[212:213], v[156:157], v[100:101], v[212:213]
    v_pk_fma_f32 v[214:215], v[152:153], v[100:101], v[214:215] neg_lo:[1,0,0] neg_hi:[1,0,0]
    v_pk_fma_f32 v[216:217], v[158:159], v[102:103], v[216:217]
    v_pk_fma_f32 v[218:219], v[154:155], v[102:103], v[218:219] neg_lo:[1,0,0] neg_hi:[1,0,0]
    v_pk_fma_f32 v[220:221], v[164:165], v[104:105], v[220:221]
    v_pk_fma_f32 v[222:223], v[160:161], v[104:105], v[222:223] neg_lo:[1,0,0] neg_hi:[1,0,0]
    v_pk_fma_f32 v[224:225], v[166:167], v[106:107], v[224:225]
    v_pk_fma_f32 v[226:227], v[162:163], v[106:107], v[226:227] neg_lo:[1,0,0] neg_hi:[1,0,0]
    v_cvt_pk_bf16_f32 v28, v212, v214
    v_cvt_pk_bf16_f32 v29, v213, v215
    v_cvt_pk_bf16_f32 v30, v216, v218
    v_cvt_pk_bf16_f32 v31, v217, v219
    v_cvt_pk_bf16_f32 v32, v220, v222
    v_cvt_pk_bf16_f32 v33, v221, v223
    v_cvt_pk_bf16_f32 v34, v224, v226
    v_cvt_pk_bf16_f32 v35, v225, v227
    v_pk_mul_f32 v[228:229], v[168:169], v[92:93]
    v_pk_mul_f32 v[230:231], v[172:173], v[92:93]
    v_pk_mul_f32 v[232:233], v[170:171], v[94:95]
    v_pk_mul_f32 v[234:235], v[174:175], v[94:95]
    v_pk_mul_f32 v[236:237], v[176:177], v[96:97]
    v_pk_mul_f32 v[238:239], v[180:181], v[96:97]
    v_pk_mul_f32 v[240:241], v[178:179], v[98:99]
    v_pk_mul_f32 v[242:243], v[182:183], v[98:99]
    v_pk_fma_f32 v[228:229], v[172:173], v[108:109], v[228:229]
    v_pk_fma_f32 v[230:231], v[168:169], v[108:109], v[230:231] neg_lo:[1,0,0] neg_hi:[1,0,0]
    v_pk_fma_f32 v[232:233], v[174:175], v[110:111], v[232:233]
    v_pk_fma_f32 v[234:235], v[170:171], v[110:111], v[234:235] neg_lo:[1,0,0] neg_hi:[1,0,0]
    v_pk_fma_f32 v[236:237], v[180:181], v[112:113], v[236:237]
    v_pk_fma_f32 v[238:239], v[176:177], v[112:113], v[238:239] neg_lo:[1,0,0] neg_hi:[1,0,0]
    v_pk_fma_f32 v[240:241], v[182:183], v[114:115], v[240:241]
    v_pk_fma_f32 v[242:243], v[178:179], v[114:115], v[242:243] neg_lo:[1,0,0] neg_hi:[1,0,0]
    v_mfma_f32_16x16x32_bf16 v[152:155], v[248:251], v[28:31], v[116:119]
    v_cvt_pk_bf16_f32 v36, v228, v230
    v_cvt_pk_bf16_f32 v37, v229, v231
    v_mfma_f32_16x16x32_bf16 v[156:159], v[148:151], v[28:31], v[120:123]
    v_cvt_pk_bf16_f32 v38, v232, v234
    v_cvt_pk_bf16_f32 v39, v233, v235
    v_mfma_f32_16x16x32_bf16 v[160:163], v[248:251], v[32:35], v[124:127]
    v_cvt_pk_bf16_f32 v40, v236, v238
    v_cvt_pk_bf16_f32 v41, v237, v239
    v_mfma_f32_16x16x32_bf16 v[164:167], v[148:151], v[32:35], v[128:131]
    v_cvt_pk_bf16_f32 v42, v240, v242
    s_nop 0
    v_cvt_pk_bf16_f32 v12, v152, v156
    v_cvt_pk_bf16_f32 v43, v241, v243
    v_cvt_pk_bf16_f32 v14, v153, v157
    v_mfma_f32_16x16x32_bf16 v[168:171], v[248:251], v[36:39], v[132:135]
    v_cvt_pk_bf16_f32 v16, v154, v158
    v_cvt_pk_bf16_f32 v18, v155, v159
    v_mfma_f32_16x16x32_bf16 v[172:175], v[148:151], v[36:39], v[136:139]
    v_cvt_pk_bf16_f32 v13, v160, v164
    buffer_store_dwordx2 v[12:13], v203, s[8:11], s30 offen
    v_cvt_pk_bf16_f32 v15, v161, v165
    v_mfma_f32_16x16x32_bf16 v[176:179], v[248:251], v[40:43], v[140:143]
    v_cvt_pk_bf16_f32 v17, v162, v166
    buffer_store_dwordx2 v[14:15], v203, s[8:11], s30 offen offset:128
    v_mfma_f32_16x16x32_bf16 v[180:183], v[148:151], v[40:43], v[144:147]
    v_cvt_pk_bf16_f32 v19, v163, v167
    v_cvt_pk_bf16_f32 v20, v168, v172
    v_cvt_pk_bf16_f32 v22, v169, v173
    v_cvt_pk_bf16_f32 v24, v170, v174
    v_cvt_pk_bf16_f32 v26, v171, v175
    s_nop 2
    v_cvt_pk_bf16_f32 v21, v176, v180
    buffer_store_dwordx2 v[16:17], v203, s[8:11], s30 offen offset:256
    v_cvt_pk_bf16_f32 v23, v177, v181
    v_cvt_pk_bf16_f32 v25, v178, v182
    v_cvt_pk_bf16_f32 v27, v179, v183
    buffer_store_dwordx2 v[18:19], v203, s[8:11], s30 offen offset:384
    buffer_store_dwordx2 v[20:21], v203, s[8:11], s31 offen
    buffer_store_dwordx2 v[22:23], v203, s[8:11], s31 offen offset:128
    buffer_store_dwordx2 v[24:25], v203, s[8:11], s31 offen offset:256
    buffer_store_dwordx2 v[26:27], v203, s[8:11], s31 offen offset:384
    s_or_b32 s58, s2, s3
    s_cmp_eq_u32 s58, 0
    s_cbranch_scc0 k_noepoch
    v_mov_b32 v5, s56
    v_mov_b32 v6, 0
    s_mov_b32 s58, 0x1214000
    s_mov_b64 exec, 1
    buffer_store_dword v5, v6, s[4:7], s58 offen sc1
    s_mov_b64 exec, -1
k_noepoch:
k_end:
    s_endpgm
code_end:
.section .rodata,"a"
.p2align 6
.amdhsa_kernel gated_mix__ssm_conv_s4d__spectral_gfnet__prompt_kernel
  .amdhsa_next_free_vgpr 440
  .amdhsa_next_free_sgpr 60
  .amdhsa_accum_offset 256
  .amdhsa_group_segment_fixed_size 0
  .amdhsa_kernarg_size 112
  .amdhsa_user_sgpr_count 2
  .amdhsa_user_sgpr_kernarg_segment_ptr 1
  .amdhsa_system_sgpr_workgroup_id_x 1
.end_amdhsa_kernel
```
